```python
import torch

def _softmax(x, axis=-1):
    return torch.softmax(x, dim=axis)
def _gelu(x):
    return torch.nn.functional.gelu(x, approximate="tanh")
def _silu(x):
    return torch.nn.functional.silu(x)
def _sigmoid(x):
    return torch.sigmoid(x)
def _layernorm(x, axis=-1, eps=1e-5):
    m = x.mean(dim=axis, keepdim=True)
    v = x.var(dim=axis, keepdim=True, unbiased=False)
    return (x - m) / torch.sqrt(v + eps)
def _scatter_add(tgt, idx, src, axis=0):
    return tgt.clone().index_add_(axis, idx, src)
def _segment_sum(src, seg, n):
    out = torch.zeros((n,) + src.shape[1:], dtype=src.dtype)
    return out.index_add_(0, seg, src)
def _pad(x, pw):
    flat = tuple(v for pair in reversed(pw) for v in pair)
    return torch.nn.functional.pad(x, flat)

kernel_name = 'gated_mix__ssm_conv_s4__dense_activation_gelu__prompt'

def setup_inputs():

    _w = (lambda a: (lambda t: t.to(torch.bfloat16) if t.is_floating_point() else t)(torch.as_tensor(a)))
    def _A_setup():
        B, L, D, N = 1, 2048, 640, 128
        A_re = -(lambda _x: torch.exp(torch.as_tensor(_x)))((lambda *s: torch.randn(*s, dtype=torch.bfloat16) * 3.2)(D, N))
        A_im = torch.pi * (lambda *s: torch.randn(*s, dtype=torch.bfloat16) * 0.05)(D, N)
        B_re = (lambda *s: torch.randn(*s, dtype=torch.bfloat16) * 0.1)(D, N)
        B_im = (lambda *s: torch.randn(*s, dtype=torch.bfloat16) * 0.1)(D, N)
        C_re = (lambda *s: torch.randn(*s, dtype=torch.bfloat16) * 0.1)(D, N)
        C_im = (lambda *s: torch.randn(*s, dtype=torch.bfloat16) * 0.1)(D, N)
        log_dt = (lambda *s: torch.randn(*s, dtype=torch.bfloat16) * 0.05)(D) * 0.5 - 4.0
        Dskip = (lambda *s: torch.randn(*s, dtype=torch.bfloat16) * 0.05)(D)
        return {
            "u": _w((lambda *s: torch.randn(*s, dtype=torch.bfloat16) * 0.05)(B, L, D)),
            "A_re": _w(A_re),
            "A_im": _w(A_im),
            "B_re": _w(B_re),
            "B_im": _w(B_im),
            "C_re": _w(C_re),
            "C_im": _w(C_im),
            "log_dt": _w(log_dt),
            "Dskip": _w(Dskip),
        }
    _A_in = _A_setup()

    def _B_setup():
        B, S, D, F = 1, 2048, 640, 1728
        return {
            "x": _w((lambda *s: torch.randn(*s, dtype=torch.bfloat16) * 0.05)(B, S, D)),
            "w1": _w((lambda *s: torch.randn(*s, dtype=torch.bfloat16) * 3.2)(D, F) * (D ** -0.5)),
            "b1": _w((lambda *s: torch.randn(*s, dtype=torch.bfloat16) * 3.2)(F) * 0.01),
            "w2": _w((lambda *s: torch.randn(*s, dtype=torch.bfloat16) * 0.1)(F, D) * (F ** -0.5)),
            "b2": _w((lambda *s: torch.randn(*s, dtype=torch.bfloat16) * 0.2)(D) * 0.01),
        }
    _B_in = _B_setup()

    return {
        "A_u": _A_in["u"],
        "A_A_re": _A_in["A_re"],
        "A_A_im": _A_in["A_im"],
        "A_B_re": _A_in["B_re"],
        "A_B_im": _A_in["B_im"],
        "A_C_re": _A_in["C_re"],
        "A_C_im": _A_in["C_im"],
        "A_log_dt": _A_in["log_dt"],
        "A_Dskip": _A_in["Dskip"],
        "B_x": _B_in["x"],
        "B_w1": _B_in["w1"],
        "B_b1": _B_in["b1"],
        "B_w2": _B_in["w2"],
        "B_b2": _B_in["b2"],
        "gate_w": _w((lambda *s: torch.randn(*s, dtype=torch.bfloat16) * 0.05)(640) * 16.0),
    }

def reference(A_u, A_A_re, A_A_im, A_B_re, A_B_im, A_C_re, A_C_im, A_log_dt, A_Dskip, B_x, B_w1, B_b1, B_w2, B_b2, gate_w):
    def _A_ref(u, A_re, A_im, B_re, B_im, C_re, C_im, log_dt, Dskip):
        Bsz, L, D = u.shape
        dt = torch.exp(log_dt)[:, None]
        A = A_re + 1j * A_im
        Bc = B_re + 1j * B_im
        Cc = C_re + 1j * C_im
        logdA = dt * A
        dB = dt * Bc
        l = (lambda x, dt: x.to(dt))(torch.arange(L), A_re.dtype)
        P = torch.exp(logdA[:, :, None] * l[None, None, :])
        K = torch.einsum("dn,dnl,dn->dl", Cc, P, dB).real
        L2 = 2 * L
        Kp = _pad(K, ((0, 0), (0, L)))
        up = (lambda x, *d: x.permute(*d))(u, 0, 2, 1)
        up = _pad(up, ((0, 0), (0, 0), (0, L)))
        Kf = (lambda x, axes=(-2,-1): torch.fft.rfft2(x.float(), dim=axes))(Kp[:, None, :], axes=(-2, -1))
        Uf = (lambda x, axes=(-2,-1): torch.fft.rfft2(x.float(), dim=axes))(up[:, :, None, :], axes=(-2, -1))
        Yf = Uf * Kf[None, :, :, :]
        y = (lambda x, s, axes=(-2,-1): torch.fft.irfft2(x, s=s, dim=axes).to(torch.bfloat16))(Yf, (1, L2), axes=(-2, -1))[:, :, 0, :L]
        y = (lambda x, *d: x.permute(*d))(y, 0, 2, 1) + u * Dskip[None, None, :]
        return y

    def _B_ref(x, w1, b1, w2, b2):
        h = torch.einsum("bsd,df->bsf", x, w1) + b1
        h = _gelu(h)
        return torch.einsum("bsf,fd->bsd", h, w2) + b2

    x = A_u
    g = _sigmoid((x * gate_w).sum(-1, keepdims=True))
    a = _A_ref(x, A_A_re, A_A_im, A_B_re, A_B_im, A_C_re, A_C_im, A_log_dt, A_Dskip)
    b = _B_ref(x, B_w1, B_b1, B_w2, B_b2)
    return g * a + (1 - g) * b
```

```asm
; @launch kernel=k1_kernel grid=(256,1,1) block=(512,1,1) lds=163840
; @launch kernel=k2_kernel grid=(256,1,1) block=(512,1,1) lds=158016
.amdgcn_target "amdgcn-amd-amdhsa--gfx950"
.text
.globl k1_kernel
.p2align 8
.type k1_kernel,@function
k1_kernel:
  s_cmp_ge_u32 s2, 8
  s_cbranch_scc1 pcs_8
  s_getpc_b64 s[82:83]
pc_7:
  s_sub_u32 s82, s82, pc_7-k1_kernel
  s_subb_u32 s83, s83, 0
  v_lshlrev_b32 v43, 7, v0
  v_min_u32 v43, code_end-k1_kernel-4, v43
  global_load_dword v242, v43, s[82:83]
pcs_8:
  s_cmp_ge_u32 s2, 256
  s_cbranch_scc1 end_1
  s_load_dwordx16 s[36:51], s[0:1], 0
  s_load_dwordx16 s[52:67], s[0:1], 64
  s_load_dwordx4 s[68:71], s[0:1], 128
  v_lshrrev_b32 v1, 6, v0
  v_and_b32 v0, 63, v0
  v_readfirstlane_b32 s3, v1
  s_and_b32 s22, s2, 7
  s_lshr_b32 s23, s2, 3
  s_cmp_ge_u32 s23, 28
  s_cbranch_scc1 spare_4
  s_cmp_ge_u32 s3, 4
  s_cbranch_scc1 help_2
  s_mul_i32 s24, s23, 37
  s_lshr_b32 s24, s24, 8
  s_mul_i32 s25, s24, 7
  s_sub_u32 s21, s23, s25
  s_and_b32 s25, s22, 1
  s_mul_i32 s25, s25, 7
  s_add_u32 s21, s21, s25
  s_lshr_b32 s20, s22, 1
  s_lshl_b32 s20, s20, 2
  s_add_u32 s20, s20, s24
  s_setprio 0
  s_lshl_b32 s27, s20, 2
  s_add_u32 s27, s27, s3
  s_mul_i32 s27, s27, 40960
  v_lshrrev_b32 v20, 3, v0
  v_mul_u32_u24 v20, 1280, v20
  v_add_u32 v20, s27, v20
  v_lshrrev_b32 v21, 4, v0
  v_and_b32 v22, 7, v0
  v_xor_b32 v22, v22, v21
  v_lshlrev_b32 v22, 4, v22
  v_xor_b32 v23, 64, v22
  v_add_u32 v2, v20, v22
  v_add_u32 v3, v20, v23
  v_add_u32 v3, 10240, v3
  v_add_u32 v4, 20480, v2
  v_add_u32 v5, 20480, v3
  s_mul_i32 s27, s3, 55296
  s_lshl_b32 s24, s21, 8
  s_add_u32 s27, s27, s24
  v_mul_u32_u24 v20, 3456, v21
  v_add_u32 v20, s27, v20
  v_and_b32 v22, 15, v0
  v_lshlrev_b32 v23, 2, v21
  v_xor_b32 v22, v22, v23
  v_lshl_add_u32 v6, v22, 4, v20
  v_add_u32 v7, 13824, v6
  v_add_u32 v8, 27648, v6
  v_add_u32 v9, 41472, v6
  s_lshl_b32 s28, s3, 12
  s_add_u32 s29, s28, 114688
  s_add_u32 s28, s28, 65536
  s_waitcnt lgkmcnt(0)
  s_mov_b32 s4, s36
  s_mov_b32 s5, s37
  s_mov_b32 s6, 0x280000
  s_mov_b32 s7, 0x00020000
  s_mov_b32 s8, s56
  s_mov_b32 s9, s57
  s_mov_b32 s10, 0x21c000
  s_mov_b32 s11, 0x00020000
  s_add_u32 m0, s28, 0
  s_mov_b32 s30, 0
  buffer_load_dwordx4 v6, s[8:11], s30 offen lds
  s_add_u32 m0, s29, 0
  s_movk_i32 s31, 0
  buffer_load_dwordx4 v2, s[4:7], s31 offen lds
  s_add_u32 m0, s28, 1024
  s_mov_b32 s30, 0
  buffer_load_dwordx4 v7, s[8:11], s30 offen lds
  s_add_u32 m0, s29, 1024
  s_movk_i32 s31, 0
  buffer_load_dwordx4 v3, s[4:7], s31 offen lds
  s_add_u32 m0, s28, 2048
  s_mov_b32 s30, 0
  buffer_load_dwordx4 v8, s[8:11], s30 offen lds
  s_add_u32 m0, s29, 2048
  s_movk_i32 s31, 0
  buffer_load_dwordx4 v4, s[4:7], s31 offen lds
  s_add_u32 m0, s28, 3072
  s_mov_b32 s30, 0
  buffer_load_dwordx4 v9, s[8:11], s30 offen lds
  s_add_u32 m0, s29, 3072
  s_movk_i32 s31, 0
  buffer_load_dwordx4 v5, s[4:7], s31 offen lds
  s_mov_b32 s12, s70
  s_mov_b32 s13, s71
  s_mov_b32 s14, 0x10000000
  s_mov_b32 s15, 0x00020000
  s_mov_b32 s16, s58
  s_mov_b32 s17, s59
  s_mov_b32 s18, 0xd80
  s_mov_b32 s19, 0x00020000
  s_lshr_b32 s22, s3, 1
  s_and_b32 s23, s3, 1
  s_lshl_b32 s27, s22, 7
  s_add_u32 s27, s27, s24
  v_lshrrev_b32 v25, 5, v0
  v_lshl_add_u32 v20, v25, 3, s27
  buffer_load_dwordx2 v[160:161], v20, s[16:19], 0 offen offset:0
  buffer_load_dwordx2 v[162:163], v20, s[16:19], 0 offen offset:16
  buffer_load_dwordx2 v[164:165], v20, s[16:19], 0 offen offset:32
  buffer_load_dwordx2 v[166:167], v20, s[16:19], 0 offen offset:48
  buffer_load_dwordx2 v[168:169], v20, s[16:19], 0 offen offset:64
  buffer_load_dwordx2 v[170:171], v20, s[16:19], 0 offen offset:80
  buffer_load_dwordx2 v[172:173], v20, s[16:19], 0 offen offset:96
  buffer_load_dwordx2 v[174:175], v20, s[16:19], 0 offen offset:112
  s_lshr_b32 s26, s2, 3
  s_lshl_b32 s26, s26, 2
  s_add_u32 s26, s26, s3
  s_mov_b32 s82, s28
  s_add_u32 m0, s28, 16384
  s_mov_b32 s30, 221184
  buffer_load_dwordx4 v6, s[8:11], s30 offen lds
  s_add_u32 m0, s29, 16384
  s_movk_i32 s31, 128
  buffer_load_dwordx4 v2, s[4:7], s31 offen lds
  s_add_u32 m0, s28, 17408
  s_mov_b32 s30, 221184
  buffer_load_dwordx4 v7, s[8:11], s30 offen lds
  s_add_u32 m0, s29, 17408
  s_movk_i32 s31, 128
  buffer_load_dwordx4 v3, s[4:7], s31 offen lds
  s_add_u32 m0, s28, 18432
  s_mov_b32 s30, 221184
  buffer_load_dwordx4 v8, s[8:11], s30 offen lds
  s_add_u32 m0, s29, 18432
  s_movk_i32 s31, 128
  buffer_load_dwordx4 v4, s[4:7], s31 offen lds
  s_add_u32 m0, s28, 19456
  s_mov_b32 s30, 221184
  buffer_load_dwordx4 v9, s[8:11], s30 offen lds
  s_add_u32 m0, s29, 19456
  s_movk_i32 s31, 128
  buffer_load_dwordx4 v5, s[4:7], s31 offen lds
  s_mul_i32 s27, s26, 32
  s_add_u32 s27, s27, 0
  v_add_u32 v40, s27, v0
  v_mul_u32_u24 v41, 18725, v40
  v_lshrrev_b32 v41, 18, v41
  v_mul_u32_u24 v42, 14, v41
  v_sub_u32 v42, v40, v42
  v_mul_u32_u24 v41, 3456, v41
  v_lshl_add_u32 v41, v42, 7, v41
  s_and_b32 s28, s2, 1
  s_mul_i32 s28, s28, 1792
  s_add_u32 s28, s28, 442368
  v_add_u32 v41, s28, v41
  v_cmp_gt_u32 vcc, 32, v0
  v_cndmask_b32 v41, -1, v41, vcc
  buffer_load_dword v240, v41, s[8:11], 0 offen
  s_mul_i32 s27, s26, 19
  s_add_u32 s27, s27, 0
  v_add_u32 v40, s27, v0
  v_mul_u32_u24 v41, 65536, v40
  v_lshrrev_b32 v41, 18, v41
  v_mul_u32_u24 v41, 768, v41
  v_lshl_add_u32 v41, v40, 7, v41
  s_bfe_u32 s28, s2, 0x20001
  s_mul_i32 s28, s28, 655360
  s_add_u32 s28, s28, 256
  v_add_u32 v41, s28, v41
  v_cmp_gt_u32 vcc, 19, v0
  v_cndmask_b32 v41, -1, v41, vcc
  v_cmp_gt_u32 vcc, 2048, v40
  v_cndmask_b32 v41, -1, v41, vcc
  buffer_load_dword v241, v41, s[4:7], 0 offen
  s_mul_i32 s27, s26, 32
  s_add_u32 s27, s27, 0
  v_add_u32 v40, s27, v0
  v_mul_u32_u24 v41, 18725, v40
  v_lshrrev_b32 v41, 18, v41
  v_mul_u32_u24 v42, 14, v41
  v_sub_u32 v42, v40, v42
  v_mul_u32_u24 v41, 3456, v41
  v_lshl_add_u32 v41, v42, 7, v41
  s_and_b32 s28, s2, 1
  s_mul_i32 s28, s28, 1792
  s_add_u32 s28, s28, 1327104
  v_add_u32 v41, s28, v41
  v_cmp_gt_u32 vcc, 32, v0
  v_cndmask_b32 v41, -1, v41, vcc
  v_mov_b32 v44, v41
  s_mul_i32 s27, s26, 19
  s_add_u32 s27, s27, 0
  v_add_u32 v40, s27, v0
  v_mul_u32_u24 v41, 65536, v40
  v_lshrrev_b32 v41, 18, v41
  v_mul_u32_u24 v41, 768, v41
  v_lshl_add_u32 v41, v40, 7, v41
  s_bfe_u32 s28, s2, 0x20001
  s_mul_i32 s28, s28, 655360
  s_add_u32 s28, s28, 768
  v_add_u32 v41, s28, v41
  v_cmp_gt_u32 vcc, 19, v0
  v_cndmask_b32 v41, -1, v41, vcc
  v_cmp_gt_u32 vcc, 2048, v40
  v_cndmask_b32 v41, -1, v41, vcc
  v_mov_b32 v45, v41
  s_mov_b32 s28, s82
  s_lshl_b32 s27, s23, 13
  s_add_u32 s27, s27, 114688
  v_and_b32 v22, 31, v0
  v_lshl_add_u32 v23, v22, 7, s27
  v_bfe_u32 v22, v0, 1, 3
  v_xor_b32 v22, v22, v25
  v_lshlrev_b32 v22, 4, v22
  v_xor_b32 v24, 0, v22
  v_add_u32 v10, v23, v24
  v_xor_b32 v24, 32, v22
  v_add_u32 v11, v23, v24
  v_xor_b32 v24, 64, v22
  v_add_u32 v12, v23, v24
  v_xor_b32 v24, 96, v22
  v_add_u32 v13, v23, v24
  v_bfe_u32 v22, v0, 2, 2
  v_lshl_add_u32 v23, v25, 3, v22
  v_lshlrev_b32 v23, 8, v23
  v_and_b32 v24, 3, v0
  v_lshl_add_u32 v23, v24, 3, v23
  v_and_b32 v24, 1, v21
  v_lshl_add_u32 v23, v24, 5, v23
  v_add_u32 v23, 65536, v23
  s_lshl_b32 s27, s22, 1
  v_xor_b32 v24, s27, v22
  v_lshl_add_u32 v14, v24, 6, v23
  v_xor_b32 v24, 1, v24
  v_lshl_add_u32 v15, v24, 6, v23
  s_lshl_b32 s27, s20, 1
  s_add_u32 s27, s27, s23
  s_mul_i32 s27, s27, 54
  s_lshl_b32 s32, s21, 2
  s_add_u32 s27, s27, s32
  s_lshl_b32 s32, s22, 1
  s_add_u32 s27, s27, s32
  s_lshl_b32 s32, s27, 12
  s_add_u32 s33, s32, 4096
  v_and_b32 v30, 15, v0
  v_lshlrev_b32 v30, 4, v30
  v_lshl_add_u32 v30, v25, 8, v30
  v_bfe_u32 v24, v0, 4, 1
  v_lshl_add_u32 v30, v24, 10, v30
  s_waitcnt vmcnt(10)
  v_lshlrev_b32 v64, 16, v160
  v_and_b32 v65, 0xffff0000, v160
  v_lshlrev_b32 v66, 16, v161
  v_and_b32 v67, 0xffff0000, v161
  v_lshlrev_b32 v80, 16, v160
  v_and_b32 v81, 0xffff0000, v160
  v_lshlrev_b32 v82, 16, v161
  v_and_b32 v83, 0xffff0000, v161
  v_lshlrev_b32 v68, 16, v162
  v_and_b32 v69, 0xffff0000, v162
  v_lshlrev_b32 v70, 16, v163
  v_and_b32 v71, 0xffff0000, v163
  v_lshlrev_b32 v84, 16, v162
  v_and_b32 v85, 0xffff0000, v162
  v_lshlrev_b32 v86, 16, v163
  v_and_b32 v87, 0xffff0000, v163
  v_lshlrev_b32 v72, 16, v164
  v_and_b32 v73, 0xffff0000, v164
  v_lshlrev_b32 v74, 16, v165
  v_and_b32 v75, 0xffff0000, v165
  v_lshlrev_b32 v88, 16, v164
  v_and_b32 v89, 0xffff0000, v164
  v_lshlrev_b32 v90, 16, v165
  v_and_b32 v91, 0xffff0000, v165
  v_lshlrev_b32 v76, 16, v166
  v_and_b32 v77, 0xffff0000, v166
  v_lshlrev_b32 v78, 16, v167
  v_and_b32 v79, 0xffff0000, v167
  v_lshlrev_b32 v92, 16, v166
  v_and_b32 v93, 0xffff0000, v166
  v_lshlrev_b32 v94, 16, v167
  v_and_b32 v95, 0xffff0000, v167
  v_lshlrev_b32 v96, 16, v168
  v_and_b32 v97, 0xffff0000, v168
  v_lshlrev_b32 v98, 16, v169
  v_and_b32 v99, 0xffff0000, v169
  v_lshlrev_b32 v112, 16, v168
  v_and_b32 v113, 0xffff0000, v168
  v_lshlrev_b32 v114, 16, v169
  v_and_b32 v115, 0xffff0000, v169
  v_lshlrev_b32 v100, 16, v170
  v_and_b32 v101, 0xffff0000, v170
  v_lshlrev_b32 v102, 16, v171
  v_and_b32 v103, 0xffff0000, v171
  v_lshlrev_b32 v116, 16, v170
  v_and_b32 v117, 0xffff0000, v170
  v_lshlrev_b32 v118, 16, v171
  v_and_b32 v119, 0xffff0000, v171
  v_lshlrev_b32 v104, 16, v172
  v_and_b32 v105, 0xffff0000, v172
  v_lshlrev_b32 v106, 16, v173
  v_and_b32 v107, 0xffff0000, v173
  v_lshlrev_b32 v120, 16, v172
  v_and_b32 v121, 0xffff0000, v172
  v_lshlrev_b32 v122, 16, v173
  v_and_b32 v123, 0xffff0000, v173
  v_lshlrev_b32 v108, 16, v174
  v_and_b32 v109, 0xffff0000, v174
  v_lshlrev_b32 v110, 16, v175
  v_and_b32 v111, 0xffff0000, v175
  v_lshlrev_b32 v124, 16, v174
  v_and_b32 v125, 0xffff0000, v174
  v_lshlrev_b32 v126, 16, v175
  v_and_b32 v127, 0xffff0000, v175
  s_barrier
  ds_read_b64_tr_b16 v[128:129], v14 offset:0
  ds_read_b64_tr_b16 v[130:131], v14 offset:1024
  ds_read_b128 v[136:139], v10 offset:0
  ds_read_b64_tr_b16 v[132:133], v15 offset:0
  ds_read_b64_tr_b16 v[134:135], v15 offset:1024
  ds_read_b128 v[140:143], v10 offset:4096
  s_add_u32 m0, s28, 32768
  s_mov_b32 s30, 442368
  buffer_load_dwordx4 v6, s[8:11], s30 offen lds
  s_add_u32 m0, s29, 32768
  s_movk_i32 s31, 256
  buffer_load_dwordx4 v2, s[4:7], s31 offen lds
  s_waitcnt lgkmcnt(0)
  v_mfma_f32_32x32x16_bf16 v[64:79], v[128:131], v[136:139], v[64:79]
  ds_read_b64_tr_b16 v[144:145], v14 offset:4096
  ds_read_b64_tr_b16 v[146:147], v14 offset:5120
  ds_read_b128 v[152:155], v11 offset:0
  v_mfma_f32_32x32x16_bf16 v[96:111], v[132:135], v[136:139], v[96:111]
  ds_read_b64_tr_b16 v[148:149], v15 offset:4096
  ds_read_b64_tr_b16 v[150:151], v15 offset:5120
  ds_read_b128 v[156:159], v11 offset:4096
  s_add_u32 m0, s28, 33792
  s_mov_b32 s30, 442368
  buffer_load_dwordx4 v7, s[8:11], s30 offen lds
  v_mfma_f32_32x32x16_bf16 v[80:95], v[128:131], v[140:143], v[80:95]
  s_add_u32 m0, s29, 33792
  s_movk_i32 s31, 256
  buffer_load_dwordx4 v3, s[4:7], s31 offen lds
  v_mfma_f32_32x32x16_bf16 v[112:127], v[132:135], v[140:143], v[112:127]
  s_waitcnt lgkmcnt(0)
  v_mfma_f32_32x32x16_bf16 v[64:79], v[144:147], v[152:155], v[64:79]
  ds_read_b64_tr_b16 v[128:129], v14 offset:8192
  ds_read_b64_tr_b16 v[130:131], v14 offset:9216
  ds_read_b128 v[136:139], v12 offset:0
  v_mfma_f32_32x32x16_bf16 v[96:111], v[148:151], v[152:155], v[96:111]
  ds_read_b64_tr_b16 v[132:133], v15 offset:8192
  ds_read_b64_tr_b16 v[134:135], v15 offset:9216
  ds_read_b128 v[140:143], v12 offset:4096
  s_add_u32 m0, s28, 34816
  s_mov_b32 s30, 442368
  buffer_load_dwordx4 v8, s[8:11], s30 offen lds
  v_mfma_f32_32x32x16_bf16 v[80:95], v[144:147], v[156:159], v[80:95]
  s_add_u32 m0, s29, 34816
  s_movk_i32 s31, 256
  buffer_load_dwordx4 v4, s[4:7], s31 offen lds
  v_mfma_f32_32x32x16_bf16 v[112:127], v[148:151], v[156:159], v[112:127]
  s_waitcnt lgkmcnt(0)
  v_mfma_f32_32x32x16_bf16 v[64:79], v[128:131], v[136:139], v[64:79]
  ds_read_b64_tr_b16 v[144:145], v14 offset:12288
  ds_read_b64_tr_b16 v[146:147], v14 offset:13312
  ds_read_b128 v[152:155], v13 offset:0
  v_mfma_f32_32x32x16_bf16 v[96:111], v[132:135], v[136:139], v[96:111]
  ds_read_b64_tr_b16 v[148:149], v15 offset:12288
  ds_read_b64_tr_b16 v[150:151], v15 offset:13312
  ds_read_b128 v[156:159], v13 offset:4096
  s_add_u32 m0, s28, 35840
  s_mov_b32 s30, 442368
  buffer_load_dwordx4 v9, s[8:11], s30 offen lds
  v_mfma_f32_32x32x16_bf16 v[80:95], v[128:131], v[140:143], v[80:95]
  s_add_u32 m0, s29, 35840
  s_movk_i32 s31, 256
  buffer_load_dwordx4 v5, s[4:7], s31 offen lds
  v_mfma_f32_32x32x16_bf16 v[112:127], v[132:135], v[140:143], v[112:127]
  s_waitcnt vmcnt(10) lgkmcnt(0)
  s_barrier
  v_mfma_f32_32x32x16_bf16 v[64:79], v[144:147], v[152:155], v[64:79]
  ds_read_b64_tr_b16 v[128:129], v14 offset:16384
  ds_read_b64_tr_b16 v[130:131], v14 offset:17408
  ds_read_b128 v[136:139], v10 offset:16384
  v_mfma_f32_32x32x16_bf16 v[96:111], v[148:151], v[152:155], v[96:111]
  ds_read_b64_tr_b16 v[132:133], v15 offset:16384
  ds_read_b64_tr_b16 v[134:135], v15 offset:17408
  ds_read_b128 v[140:143], v10 offset:20480
  s_add_u32 m0, s28, 0
  s_mov_b32 s30, 663552
  buffer_load_dwordx4 v6, s[8:11], s30 offen lds
  v_mfma_f32_32x32x16_bf16 v[80:95], v[144:147], v[156:159], v[80:95]
  s_add_u32 m0, s29, 0
  s_movk_i32 s31, 384
  buffer_load_dwordx4 v2, s[4:7], s31 offen lds
  v_mfma_f32_32x32x16_bf16 v[112:127], v[148:151], v[156:159], v[112:127]
  s_waitcnt lgkmcnt(0)
  v_mfma_f32_32x32x16_bf16 v[64:79], v[128:131], v[136:139], v[64:79]
  ds_read_b64_tr_b16 v[144:145], v14 offset:20480
  ds_read_b64_tr_b16 v[146:147], v14 offset:21504
  ds_read_b128 v[152:155], v11 offset:16384
  v_mfma_f32_32x32x16_bf16 v[96:111], v[132:135], v[136:139], v[96:111]
  ds_read_b64_tr_b16 v[148:149], v15 offset:20480
  ds_read_b64_tr_b16 v[150:151], v15 offset:21504
  ds_read_b128 v[156:159], v11 offset:20480
  s_add_u32 m0, s28, 1024
  s_mov_b32 s30, 663552
  buffer_load_dwordx4 v7, s[8:11], s30 offen lds
  v_mfma_f32_32x32x16_bf16 v[80:95], v[128:131], v[140:143], v[80:95]
  s_add_u32 m0, s29, 1024
  s_movk_i32 s31, 384
  buffer_load_dwordx4 v3, s[4:7], s31 offen lds
  v_mfma_f32_32x32x16_bf16 v[112:127], v[132:135], v[140:143], v[112:127]
  s_waitcnt lgkmcnt(0)
  v_mfma_f32_32x32x16_bf16 v[64:79], v[144:147], v[152:155], v[64:79]
  ds_read_b64_tr_b16 v[128:129], v14 offset:24576
  ds_read_b64_tr_b16 v[130:131], v14 offset:25600
  ds_read_b128 v[136:139], v12 offset:16384
  v_mfma_f32_32x32x16_bf16 v[96:111], v[148:151], v[152:155], v[96:111]
  ds_read_b64_tr_b16 v[132:133], v15 offset:24576
  ds_read_b64_tr_b16 v[134:135], v15 offset:25600
  ds_read_b128 v[140:143], v12 offset:20480
  s_add_u32 m0, s28, 2048
  s_mov_b32 s30, 663552
  buffer_load_dwordx4 v8, s[8:11], s30 offen lds
  v_mfma_f32_32x32x16_bf16 v[80:95], v[144:147], v[156:159], v[80:95]
  s_add_u32 m0, s29, 2048
  s_movk_i32 s31, 384
  buffer_load_dwordx4 v4, s[4:7], s31 offen lds
  v_mfma_f32_32x32x16_bf16 v[112:127], v[148:151], v[156:159], v[112:127]
  s_waitcnt lgkmcnt(0)
  v_mfma_f32_32x32x16_bf16 v[64:79], v[128:131], v[136:139], v[64:79]
  ds_read_b64_tr_b16 v[144:145], v14 offset:28672
  ds_read_b64_tr_b16 v[146:147], v14 offset:29696
  ds_read_b128 v[152:155], v13 offset:16384
  v_mfma_f32_32x32x16_bf16 v[96:111], v[132:135], v[136:139], v[96:111]
  ds_read_b64_tr_b16 v[148:149], v15 offset:28672
  ds_read_b64_tr_b16 v[150:151], v15 offset:29696
  ds_read_b128 v[156:159], v13 offset:20480
  s_add_u32 m0, s28, 3072
  s_mov_b32 s30, 663552
  buffer_load_dwordx4 v9, s[8:11], s30 offen lds
  v_mfma_f32_32x32x16_bf16 v[80:95], v[128:131], v[140:143], v[80:95]
  s_add_u32 m0, s29, 3072
  s_movk_i32 s31, 384
  buffer_load_dwordx4 v5, s[4:7], s31 offen lds
  v_mfma_f32_32x32x16_bf16 v[112:127], v[132:135], v[140:143], v[112:127]
  buffer_load_dword v244, v44, s[8:11], 0 offen
  buffer_load_dword v245, v45, s[4:7], 0 offen
  s_waitcnt vmcnt(10) lgkmcnt(0)
  s_barrier
  v_mfma_f32_32x32x16_bf16 v[64:79], v[144:147], v[152:155], v[64:79]
  ds_read_b64_tr_b16 v[128:129], v14 offset:32768
  ds_read_b64_tr_b16 v[130:131], v14 offset:33792
  ds_read_b128 v[136:139], v10 offset:32768
  v_mfma_f32_32x32x16_bf16 v[96:111], v[148:151], v[152:155], v[96:111]
  ds_read_b64_tr_b16 v[132:133], v15 offset:32768
  ds_read_b64_tr_b16 v[134:135], v15 offset:33792
  ds_read_b128 v[140:143], v10 offset:36864
  s_add_u32 m0, s28, 16384
  s_mov_b32 s30, 884736
  buffer_load_dwordx4 v6, s[8:11], s30 offen lds
  v_mfma_f32_32x32x16_bf16 v[80:95], v[144:147], v[156:159], v[80:95]
  s_add_u32 m0, s29, 16384
  s_movk_i32 s31, 512
  buffer_load_dwordx4 v2, s[4:7], s31 offen lds
  v_mfma_f32_32x32x16_bf16 v[112:127], v[148:151], v[156:159], v[112:127]
  s_waitcnt lgkmcnt(0)
  v_mfma_f32_32x32x16_bf16 v[64:79], v[128:131], v[136:139], v[64:79]
  ds_read_b64_tr_b16 v[144:145], v14 offset:36864
  ds_read_b64_tr_b16 v[146:147], v14 offset:37888
  ds_read_b128 v[152:155], v11 offset:32768
  v_mfma_f32_32x32x16_bf16 v[96:111], v[132:135], v[136:139], v[96:111]
  ds_read_b64_tr_b16 v[148:149], v15 offset:36864
  ds_read_b64_tr_b16 v[150:151], v15 offset:37888
  ds_read_b128 v[156:159], v11 offset:36864
  s_add_u32 m0, s28, 17408
  s_mov_b32 s30, 884736
  buffer_load_dwordx4 v7, s[8:11], s30 offen lds
  v_mfma_f32_32x32x16_bf16 v[80:95], v[128:131], v[140:143], v[80:95]
  s_add_u32 m0, s29, 17408
  s_movk_i32 s31, 512
  buffer_load_dwordx4 v3, s[4:7], s31 offen lds
  v_mfma_f32_32x32x16_bf16 v[112:127], v[132:135], v[140:143], v[112:127]
  s_waitcnt lgkmcnt(0)
  v_mfma_f32_32x32x16_bf16 v[64:79], v[144:147], v[152:155], v[64:79]
  ds_read_b64_tr_b16 v[128:129], v14 offset:40960
  ds_read_b64_tr_b16 v[130:131], v14 offset:41984
  ds_read_b128 v[136:139], v12 offset:32768
  v_mfma_f32_32x32x16_bf16 v[96:111], v[148:151], v[152:155], v[96:111]
  ds_read_b64_tr_b16 v[132:133], v15 offset:40960
  ds_read_b64_tr_b16 v[134:135], v15 offset:41984
  ds_read_b128 v[140:143], v12 offset:36864
  s_add_u32 m0, s28, 18432
  s_mov_b32 s30, 884736
  buffer_load_dwordx4 v8, s[8:11], s30 offen lds
  v_mfma_f32_32x32x16_bf16 v[80:95], v[144:147], v[156:159], v[80:95]
  s_add_u32 m0, s29, 18432
  s_movk_i32 s31, 512
  buffer_load_dwordx4 v4, s[4:7], s31 offen lds
  v_mfma_f32_32x32x16_bf16 v[112:127], v[148:151], v[156:159], v[112:127]
  s_waitcnt lgkmcnt(0)
  v_mfma_f32_32x32x16_bf16 v[64:79], v[128:131], v[136:139], v[64:79]
  ds_read_b64_tr_b16 v[144:145], v14 offset:45056
  ds_read_b64_tr_b16 v[146:147], v14 offset:46080
  ds_read_b128 v[152:155], v13 offset:32768
  v_mfma_f32_32x32x16_bf16 v[96:111], v[132:135], v[136:139], v[96:111]
  ds_read_b64_tr_b16 v[148:149], v15 offset:45056
  ds_read_b64_tr_b16 v[150:151], v15 offset:46080
  ds_read_b128 v[156:159], v13 offset:36864
  s_add_u32 m0, s28, 19456
  s_mov_b32 s30, 884736
  buffer_load_dwordx4 v9, s[8:11], s30 offen lds
  v_mfma_f32_32x32x16_bf16 v[80:95], v[128:131], v[140:143], v[80:95]
  s_add_u32 m0, s29, 19456
  s_movk_i32 s31, 512
  buffer_load_dwordx4 v5, s[4:7], s31 offen lds
  v_mfma_f32_32x32x16_bf16 v[112:127], v[132:135], v[140:143], v[112:127]
  s_waitcnt vmcnt(10) lgkmcnt(0)
  s_barrier
  v_mfma_f32_32x32x16_bf16 v[64:79], v[144:147], v[152:155], v[64:79]
  ds_read_b64_tr_b16 v[128:129], v14 offset:0
  ds_read_b64_tr_b16 v[130:131], v14 offset:1024
  ds_read_b128 v[136:139], v10 offset:0
  v_mfma_f32_32x32x16_bf16 v[96:111], v[148:151], v[152:155], v[96:111]
  ds_read_b64_tr_b16 v[132:133], v15 offset:0
  ds_read_b64_tr_b16 v[134:135], v15 offset:1024
  ds_read_b128 v[140:143], v10 offset:4096
  s_add_u32 m0, s28, 32768
  s_mov_b32 s30, 1105920
  buffer_load_dwordx4 v6, s[8:11], s30 offen lds
  v_mfma_f32_32x32x16_bf16 v[80:95], v[144:147], v[156:159], v[80:95]
  s_add_u32 m0, s29, 32768
  s_movk_i32 s31, 640
  buffer_load_dwordx4 v2, s[4:7], s31 offen lds
  v_mfma_f32_32x32x16_bf16 v[112:127], v[148:151], v[156:159], v[112:127]
  s_waitcnt lgkmcnt(0)
  v_mfma_f32_32x32x16_bf16 v[64:79], v[128:131], v[136:139], v[64:79]
  ds_read_b64_tr_b16 v[144:145], v14 offset:4096
  ds_read_b64_tr_b16 v[146:147], v14 offset:5120
  ds_read_b128 v[152:155], v11 offset:0
  v_mfma_f32_32x32x16_bf16 v[96:111], v[132:135], v[136:139], v[96:111]
  ds_read_b64_tr_b16 v[148:149], v15 offset:4096
  ds_read_b64_tr_b16 v[150:151], v15 offset:5120
  ds_read_b128 v[156:159], v11 offset:4096
  s_add_u32 m0, s28, 33792
  s_mov_b32 s30, 1105920
  buffer_load_dwordx4 v7, s[8:11], s30 offen lds
  v_mfma_f32_32x32x16_bf16 v[80:95], v[128:131], v[140:143], v[80:95]
  s_add_u32 m0, s29, 33792
  s_movk_i32 s31, 640
  buffer_load_dwordx4 v3, s[4:7], s31 offen lds
  v_mfma_f32_32x32x16_bf16 v[112:127], v[132:135], v[140:143], v[112:127]
  s_waitcnt lgkmcnt(0)
  v_mfma_f32_32x32x16_bf16 v[64:79], v[144:147], v[152:155], v[64:79]
  ds_read_b64_tr_b16 v[128:129], v14 offset:8192
  ds_read_b64_tr_b16 v[130:131], v14 offset:9216
  ds_read_b128 v[136:139], v12 offset:0
  v_mfma_f32_32x32x16_bf16 v[96:111], v[148:151], v[152:155], v[96:111]
  ds_read_b64_tr_b16 v[132:133], v15 offset:8192
  ds_read_b64_tr_b16 v[134:135], v15 offset:9216
  ds_read_b128 v[140:143], v12 offset:4096
  s_add_u32 m0, s28, 34816
  s_mov_b32 s30, 1105920
  buffer_load_dwordx4 v8, s[8:11], s30 offen lds
  v_mfma_f32_32x32x16_bf16 v[80:95], v[144:147], v[156:159], v[80:95]
  s_add_u32 m0, s29, 34816
  s_movk_i32 s31, 640
  buffer_load_dwordx4 v4, s[4:7], s31 offen lds
  v_mfma_f32_32x32x16_bf16 v[112:127], v[148:151], v[156:159], v[112:127]
  s_waitcnt lgkmcnt(0)
  v_mfma_f32_32x32x16_bf16 v[64:79], v[128:131], v[136:139], v[64:79]
  ds_read_b64_tr_b16 v[144:145], v14 offset:12288
  ds_read_b64_tr_b16 v[146:147], v14 offset:13312
  ds_read_b128 v[152:155], v13 offset:0
  v_mfma_f32_32x32x16_bf16 v[96:111], v[132:135], v[136:139], v[96:111]
  ds_read_b64_tr_b16 v[148:149], v15 offset:12288
  ds_read_b64_tr_b16 v[150:151], v15 offset:13312
  ds_read_b128 v[156:159], v13 offset:4096
  s_add_u32 m0, s28, 35840
  s_mov_b32 s30, 1105920
  buffer_load_dwordx4 v9, s[8:11], s30 offen lds
  v_mfma_f32_32x32x16_bf16 v[80:95], v[128:131], v[140:143], v[80:95]
  s_add_u32 m0, s29, 35840
  s_movk_i32 s31, 640
  buffer_load_dwordx4 v5, s[4:7], s31 offen lds
  v_mfma_f32_32x32x16_bf16 v[112:127], v[132:135], v[140:143], v[112:127]
  s_waitcnt vmcnt(8) lgkmcnt(0)
  s_barrier
  v_mfma_f32_32x32x16_bf16 v[64:79], v[144:147], v[152:155], v[64:79]
  ds_read_b64_tr_b16 v[128:129], v14 offset:16384
  ds_read_b64_tr_b16 v[130:131], v14 offset:17408
  ds_read_b128 v[136:139], v10 offset:16384
  v_mfma_f32_32x32x16_bf16 v[96:111], v[148:151], v[152:155], v[96:111]
  ds_read_b64_tr_b16 v[132:133], v15 offset:16384
  ds_read_b64_tr_b16 v[134:135], v15 offset:17408
  ds_read_b128 v[140:143], v10 offset:20480
  s_add_u32 m0, s28, 0
  s_mov_b32 s30, 1327104
  buffer_load_dwordx4 v6, s[8:11], s30 offen lds
  v_mfma_f32_32x32x16_bf16 v[80:95], v[144:147], v[156:159], v[80:95]
  s_add_u32 m0, s29, 0
  s_movk_i32 s31, 768
  buffer_load_dwordx4 v2, s[4:7], s31 offen lds
  v_mfma_f32_32x32x16_bf16 v[112:127], v[148:151], v[156:159], v[112:127]
  s_waitcnt lgkmcnt(0)
  v_mfma_f32_32x32x16_bf16 v[64:79], v[128:131], v[136:139], v[64:79]
  ds_read_b64_tr_b16 v[144:145], v14 offset:20480
  ds_read_b64_tr_b16 v[146:147], v14 offset:21504
  ds_read_b128 v[152:155], v11 offset:16384
  v_mfma_f32_32x32x16_bf16 v[96:111], v[132:135], v[136:139], v[96:111]
  ds_read_b64_tr_b16 v[148:149], v15 offset:20480
  ds_read_b64_tr_b16 v[150:151], v15 offset:21504
  ds_read_b128 v[156:159], v11 offset:20480
  s_add_u32 m0, s28, 1024
  s_mov_b32 s30, 1327104
  buffer_load_dwordx4 v7, s[8:11], s30 offen lds
  v_mfma_f32_32x32x16_bf16 v[80:95], v[128:131], v[140:143], v[80:95]
  s_add_u32 m0, s29, 1024
  s_movk_i32 s31, 768
  buffer_load_dwordx4 v3, s[4:7], s31 offen lds
  v_mfma_f32_32x32x16_bf16 v[112:127], v[132:135], v[140:143], v[112:127]
  s_waitcnt lgkmcnt(0)
  v_mfma_f32_32x32x16_bf16 v[64:79], v[144:147], v[152:155], v[64:79]
  ds_read_b64_tr_b16 v[128:129], v14 offset:24576
  ds_read_b64_tr_b16 v[130:131], v14 offset:25600
  ds_read_b128 v[136:139], v12 offset:16384
  v_mfma_f32_32x32x16_bf16 v[96:111], v[148:151], v[152:155], v[96:111]
  ds_read_b64_tr_b16 v[132:133], v15 offset:24576
  ds_read_b64_tr_b16 v[134:135], v15 offset:25600
  ds_read_b128 v[140:143], v12 offset:20480
  s_add_u32 m0, s28, 2048
  s_mov_b32 s30, 1327104
  buffer_load_dwordx4 v8, s[8:11], s30 offen lds
  v_mfma_f32_32x32x16_bf16 v[80:95], v[144:147], v[156:159], v[80:95]
  s_add_u32 m0, s29, 2048
  s_movk_i32 s31, 768
  buffer_load_dwordx4 v4, s[4:7], s31 offen lds
  v_mfma_f32_32x32x16_bf16 v[112:127], v[148:151], v[156:159], v[112:127]
  s_waitcnt lgkmcnt(0)
  v_mfma_f32_32x32x16_bf16 v[64:79], v[128:131], v[136:139], v[64:79]
  ds_read_b64_tr_b16 v[144:145], v14 offset:28672
  ds_read_b64_tr_b16 v[146:147], v14 offset:29696
  ds_read_b128 v[152:155], v13 offset:16384
  v_mfma_f32_32x32x16_bf16 v[96:111], v[132:135], v[136:139], v[96:111]
  ds_read_b64_tr_b16 v[148:149], v15 offset:28672
  ds_read_b64_tr_b16 v[150:151], v15 offset:29696
  ds_read_b128 v[156:159], v13 offset:20480
  s_add_u32 m0, s28, 3072
  s_mov_b32 s30, 1327104
  buffer_load_dwordx4 v9, s[8:11], s30 offen lds
  v_mfma_f32_32x32x16_bf16 v[80:95], v[128:131], v[140:143], v[80:95]
  s_add_u32 m0, s29, 3072
  s_movk_i32 s31, 768
  buffer_load_dwordx4 v5, s[4:7], s31 offen lds
  v_mfma_f32_32x32x16_bf16 v[112:127], v[132:135], v[140:143], v[112:127]
  s_waitcnt vmcnt(8) lgkmcnt(0)
  s_barrier
  v_mfma_f32_32x32x16_bf16 v[64:79], v[144:147], v[152:155], v[64:79]
  ds_read_b64_tr_b16 v[128:129], v14 offset:32768
  ds_read_b64_tr_b16 v[130:131], v14 offset:33792
  ds_read_b128 v[136:139], v10 offset:32768
  v_mfma_f32_32x32x16_bf16 v[96:111], v[148:151], v[152:155], v[96:111]
  ds_read_b64_tr_b16 v[132:133], v15 offset:32768
  ds_read_b64_tr_b16 v[134:135], v15 offset:33792
  ds_read_b128 v[140:143], v10 offset:36864
  s_add_u32 m0, s28, 16384
  s_mov_b32 s30, 1548288
  buffer_load_dwordx4 v6, s[8:11], s30 offen lds
  v_mfma_f32_32x32x16_bf16 v[80:95], v[144:147], v[156:159], v[80:95]
  s_add_u32 m0, s29, 16384
  s_movk_i32 s31, 896
  buffer_load_dwordx4 v2, s[4:7], s31 offen lds
  v_mfma_f32_32x32x16_bf16 v[112:127], v[148:151], v[156:159], v[112:127]
  s_waitcnt lgkmcnt(0)
  v_mfma_f32_32x32x16_bf16 v[64:79], v[128:131], v[136:139], v[64:79]
  ds_read_b64_tr_b16 v[144:145], v14 offset:36864
  ds_read_b64_tr_b16 v[146:147], v14 offset:37888
  ds_read_b128 v[152:155], v11 offset:32768
  v_mfma_f32_32x32x16_bf16 v[96:111], v[132:135], v[136:139], v[96:111]
  ds_read_b64_tr_b16 v[148:149], v15 offset:36864
  ds_read_b64_tr_b16 v[150:151], v15 offset:37888
  ds_read_b128 v[156:159], v11 offset:36864
  s_add_u32 m0, s28, 17408
  s_mov_b32 s30, 1548288
  buffer_load_dwordx4 v7, s[8:11], s30 offen lds
  v_mfma_f32_32x32x16_bf16 v[80:95], v[128:131], v[140:143], v[80:95]
  s_add_u32 m0, s29, 17408
  s_movk_i32 s31, 896
  buffer_load_dwordx4 v3, s[4:7], s31 offen lds
  v_mfma_f32_32x32x16_bf16 v[112:127], v[132:135], v[140:143], v[112:127]
  s_waitcnt lgkmcnt(0)
  v_mfma_f32_32x32x16_bf16 v[64:79], v[144:147], v[152:155], v[64:79]
  ds_read_b64_tr_b16 v[128:129], v14 offset:40960
  ds_read_b64_tr_b16 v[130:131], v14 offset:41984
  ds_read_b128 v[136:139], v12 offset:32768
  v_mfma_f32_32x32x16_bf16 v[96:111], v[148:151], v[152:155], v[96:111]
  ds_read_b64_tr_b16 v[132:133], v15 offset:40960
  ds_read_b64_tr_b16 v[134:135], v15 offset:41984
  ds_read_b128 v[140:143], v12 offset:36864
  s_add_u32 m0, s28, 18432
  s_mov_b32 s30, 1548288
  buffer_load_dwordx4 v8, s[8:11], s30 offen lds
  v_mfma_f32_32x32x16_bf16 v[80:95], v[144:147], v[156:159], v[80:95]
  s_add_u32 m0, s29, 18432
  s_movk_i32 s31, 896
  buffer_load_dwordx4 v4, s[4:7], s31 offen lds
  v_mfma_f32_32x32x16_bf16 v[112:127], v[148:151], v[156:159], v[112:127]
  s_waitcnt lgkmcnt(0)
  v_mfma_f32_32x32x16_bf16 v[64:79], v[128:131], v[136:139], v[64:79]
  ds_read_b64_tr_b16 v[144:145], v14 offset:45056
  ds_read_b64_tr_b16 v[146:147], v14 offset:46080
  ds_read_b128 v[152:155], v13 offset:32768
  v_mfma_f32_32x32x16_bf16 v[96:111], v[132:135], v[136:139], v[96:111]
  ds_read_b64_tr_b16 v[148:149], v15 offset:45056
  ds_read_b64_tr_b16 v[150:151], v15 offset:46080
  ds_read_b128 v[156:159], v13 offset:36864
  s_add_u32 m0, s28, 19456
  s_mov_b32 s30, 1548288
  buffer_load_dwordx4 v9, s[8:11], s30 offen lds
  v_mfma_f32_32x32x16_bf16 v[80:95], v[128:131], v[140:143], v[80:95]
  s_add_u32 m0, s29, 19456
  s_movk_i32 s31, 896
  buffer_load_dwordx4 v5, s[4:7], s31 offen lds
  v_mfma_f32_32x32x16_bf16 v[112:127], v[132:135], v[140:143], v[112:127]
  s_waitcnt vmcnt(8) lgkmcnt(0)
  s_barrier
  v_mfma_f32_32x32x16_bf16 v[64:79], v[144:147], v[152:155], v[64:79]
  ds_read_b64_tr_b16 v[128:129], v14 offset:0
  ds_read_b64_tr_b16 v[130:131], v14 offset:1024
  ds_read_b128 v[136:139], v10 offset:0
  v_mfma_f32_32x32x16_bf16 v[96:111], v[148:151], v[152:155], v[96:111]
  ds_read_b64_tr_b16 v[132:133], v15 offset:0
  ds_read_b64_tr_b16 v[134:135], v15 offset:1024
  ds_read_b128 v[140:143], v10 offset:4096
  s_add_u32 m0, s28, 32768
  s_mov_b32 s30, 1769472
  buffer_load_dwordx4 v6, s[8:11], s30 offen lds
  v_mfma_f32_32x32x16_bf16 v[80:95], v[144:147], v[156:159], v[80:95]
  s_add_u32 m0, s29, 32768
  s_movk_i32 s31, 1024
  buffer_load_dwordx4 v2, s[4:7], s31 offen lds
  v_mfma_f32_32x32x16_bf16 v[112:127], v[148:151], v[156:159], v[112:127]
  s_waitcnt lgkmcnt(0)
  v_mfma_f32_32x32x16_bf16 v[64:79], v[128:131], v[136:139], v[64:79]
  ds_read_b64_tr_b16 v[144:145], v14 offset:4096
  ds_read_b64_tr_b16 v[146:147], v14 offset:5120
  ds_read_b128 v[152:155], v11 offset:0
  v_mfma_f32_32x32x16_bf16 v[96:111], v[132:135], v[136:139], v[96:111]
  ds_read_b64_tr_b16 v[148:149], v15 offset:4096
  ds_read_b64_tr_b16 v[150:151], v15 offset:5120
  ds_read_b128 v[156:159], v11 offset:4096
  s_add_u32 m0, s28, 33792
  s_mov_b32 s30, 1769472
  buffer_load_dwordx4 v7, s[8:11], s30 offen lds
  v_mfma_f32_32x32x16_bf16 v[80:95], v[128:131], v[140:143], v[80:95]
  s_add_u32 m0, s29, 33792
  s_movk_i32 s31, 1024
  buffer_load_dwordx4 v3, s[4:7], s31 offen lds
  v_mfma_f32_32x32x16_bf16 v[112:127], v[132:135], v[140:143], v[112:127]
  s_waitcnt lgkmcnt(0)
  v_mfma_f32_32x32x16_bf16 v[64:79], v[144:147], v[152:155], v[64:79]
  ds_read_b64_tr_b16 v[128:129], v14 offset:8192
  ds_read_b64_tr_b16 v[130:131], v14 offset:9216
  ds_read_b128 v[136:139], v12 offset:0
  v_mfma_f32_32x32x16_bf16 v[96:111], v[148:151], v[152:155], v[96:111]
  ds_read_b64_tr_b16 v[132:133], v15 offset:8192
  ds_read_b64_tr_b16 v[134:135], v15 offset:9216
  ds_read_b128 v[140:143], v12 offset:4096
  s_add_u32 m0, s28, 34816
  s_mov_b32 s30, 1769472
  buffer_load_dwordx4 v8, s[8:11], s30 offen lds
  v_mfma_f32_32x32x16_bf16 v[80:95], v[144:147], v[156:159], v[80:95]
  s_add_u32 m0, s29, 34816
  s_movk_i32 s31, 1024
  buffer_load_dwordx4 v4, s[4:7], s31 offen lds
  v_mfma_f32_32x32x16_bf16 v[112:127], v[148:151], v[156:159], v[112:127]
  s_waitcnt lgkmcnt(0)
  v_mfma_f32_32x32x16_bf16 v[64:79], v[128:131], v[136:139], v[64:79]
  ds_read_b64_tr_b16 v[144:145], v14 offset:12288
  ds_read_b64_tr_b16 v[146:147], v14 offset:13312
  ds_read_b128 v[152:155], v13 offset:0
  v_mfma_f32_32x32x16_bf16 v[96:111], v[132:135], v[136:139], v[96:111]
  ds_read_b64_tr_b16 v[148:149], v15 offset:12288
  ds_read_b64_tr_b16 v[150:151], v15 offset:13312
  ds_read_b128 v[156:159], v13 offset:4096
  s_add_u32 m0, s28, 35840
  s_mov_b32 s30, 1769472
  buffer_load_dwordx4 v9, s[8:11], s30 offen lds
  v_mfma_f32_32x32x16_bf16 v[80:95], v[128:131], v[140:143], v[80:95]
  s_add_u32 m0, s29, 35840
  s_movk_i32 s31, 1024
  buffer_load_dwordx4 v5, s[4:7], s31 offen lds
  v_mfma_f32_32x32x16_bf16 v[112:127], v[132:135], v[140:143], v[112:127]
  s_waitcnt vmcnt(8) lgkmcnt(0)
  s_barrier
  v_mfma_f32_32x32x16_bf16 v[64:79], v[144:147], v[152:155], v[64:79]
  ds_read_b64_tr_b16 v[128:129], v14 offset:16384
  ds_read_b64_tr_b16 v[130:131], v14 offset:17408
  ds_read_b128 v[136:139], v10 offset:16384
  v_mfma_f32_32x32x16_bf16 v[96:111], v[148:151], v[152:155], v[96:111]
  ds_read_b64_tr_b16 v[132:133], v15 offset:16384
  ds_read_b64_tr_b16 v[134:135], v15 offset:17408
  ds_read_b128 v[140:143], v10 offset:20480
  s_add_u32 m0, s28, 0
  s_mov_b32 s30, 1990656
  buffer_load_dwordx4 v6, s[8:11], s30 offen lds
  v_mfma_f32_32x32x16_bf16 v[80:95], v[144:147], v[156:159], v[80:95]
  s_add_u32 m0, s29, 0
  s_movk_i32 s31, 1152
  buffer_load_dwordx4 v2, s[4:7], s31 offen lds
  v_mfma_f32_32x32x16_bf16 v[112:127], v[148:151], v[156:159], v[112:127]
  s_waitcnt lgkmcnt(0)
  v_mfma_f32_32x32x16_bf16 v[64:79], v[128:131], v[136:139], v[64:79]
  ds_read_b64_tr_b16 v[144:145], v14 offset:20480
  ds_read_b64_tr_b16 v[146:147], v14 offset:21504
  ds_read_b128 v[152:155], v11 offset:16384
  v_mfma_f32_32x32x16_bf16 v[96:111], v[132:135], v[136:139], v[96:111]
  ds_read_b64_tr_b16 v[148:149], v15 offset:20480
  ds_read_b64_tr_b16 v[150:151], v15 offset:21504
  ds_read_b128 v[156:159], v11 offset:20480
  s_add_u32 m0, s28, 1024
  s_mov_b32 s30, 1990656
  buffer_load_dwordx4 v7, s[8:11], s30 offen lds
  v_mfma_f32_32x32x16_bf16 v[80:95], v[128:131], v[140:143], v[80:95]
  s_add_u32 m0, s29, 1024
  s_movk_i32 s31, 1152
  buffer_load_dwordx4 v3, s[4:7], s31 offen lds
  v_mfma_f32_32x32x16_bf16 v[112:127], v[132:135], v[140:143], v[112:127]
  s_waitcnt lgkmcnt(0)
  v_mfma_f32_32x32x16_bf16 v[64:79], v[144:147], v[152:155], v[64:79]
  ds_read_b64_tr_b16 v[128:129], v14 offset:24576
  ds_read_b64_tr_b16 v[130:131], v14 offset:25600
  ds_read_b128 v[136:139], v12 offset:16384
  v_mfma_f32_32x32x16_bf16 v[96:111], v[148:151], v[152:155], v[96:111]
  ds_read_b64_tr_b16 v[132:133], v15 offset:24576
  ds_read_b64_tr_b16 v[134:135], v15 offset:25600
  ds_read_b128 v[140:143], v12 offset:20480
  s_add_u32 m0, s28, 2048
  s_mov_b32 s30, 1990656
  buffer_load_dwordx4 v8, s[8:11], s30 offen lds
  v_mfma_f32_32x32x16_bf16 v[80:95], v[144:147], v[156:159], v[80:95]
  s_add_u32 m0, s29, 2048
  s_movk_i32 s31, 1152
  buffer_load_dwordx4 v4, s[4:7], s31 offen lds
  v_mfma_f32_32x32x16_bf16 v[112:127], v[148:151], v[156:159], v[112:127]
  s_waitcnt lgkmcnt(0)
  v_mfma_f32_32x32x16_bf16 v[64:79], v[128:131], v[136:139], v[64:79]
  ds_read_b64_tr_b16 v[144:145], v14 offset:28672
  ds_read_b64_tr_b16 v[146:147], v14 offset:29696
  ds_read_b128 v[152:155], v13 offset:16384
  v_mfma_f32_32x32x16_bf16 v[96:111], v[132:135], v[136:139], v[96:111]
  ds_read_b64_tr_b16 v[148:149], v15 offset:28672
  ds_read_b64_tr_b16 v[150:151], v15 offset:29696
  ds_read_b128 v[156:159], v13 offset:20480
  s_add_u32 m0, s28, 3072
  s_mov_b32 s30, 1990656
  buffer_load_dwordx4 v9, s[8:11], s30 offen lds
  v_mfma_f32_32x32x16_bf16 v[80:95], v[128:131], v[140:143], v[80:95]
  s_add_u32 m0, s29, 3072
  s_movk_i32 s31, 1152
  buffer_load_dwordx4 v5, s[4:7], s31 offen lds
  v_mfma_f32_32x32x16_bf16 v[112:127], v[132:135], v[140:143], v[112:127]
  s_waitcnt vmcnt(8) lgkmcnt(0)
  s_barrier
  v_mfma_f32_32x32x16_bf16 v[64:79], v[144:147], v[152:155], v[64:79]
  ds_read_b64_tr_b16 v[128:129], v14 offset:32768
  ds_read_b64_tr_b16 v[130:131], v14 offset:33792
  ds_read_b128 v[136:139], v10 offset:32768
  v_mfma_f32_32x32x16_bf16 v[96:111], v[148:151], v[152:155], v[96:111]
  ds_read_b64_tr_b16 v[132:133], v15 offset:32768
  ds_read_b64_tr_b16 v[134:135], v15 offset:33792
  ds_read_b128 v[140:143], v10 offset:36864
  v_mfma_f32_32x32x16_bf16 v[80:95], v[144:147], v[156:159], v[80:95]
  v_mfma_f32_32x32x16_bf16 v[112:127], v[148:151], v[156:159], v[112:127]
  s_waitcnt lgkmcnt(0)
  v_mfma_f32_32x32x16_bf16 v[64:79], v[128:131], v[136:139], v[64:79]
  ds_read_b64_tr_b16 v[144:145], v14 offset:36864
  ds_read_b64_tr_b16 v[146:147], v14 offset:37888
  ds_read_b128 v[152:155], v11 offset:32768
  v_mfma_f32_32x32x16_bf16 v[96:111], v[132:135], v[136:139], v[96:111]
  ds_read_b64_tr_b16 v[148:149], v15 offset:36864
  ds_read_b64_tr_b16 v[150:151], v15 offset:37888
  ds_read_b128 v[156:159], v11 offset:36864
  v_mfma_f32_32x32x16_bf16 v[80:95], v[128:131], v[140:143], v[80:95]
  v_mfma_f32_32x32x16_bf16 v[112:127], v[132:135], v[140:143], v[112:127]
  s_waitcnt lgkmcnt(0)
  v_mfma_f32_32x32x16_bf16 v[64:79], v[144:147], v[152:155], v[64:79]
  ds_read_b64_tr_b16 v[128:129], v14 offset:40960
  ds_read_b64_tr_b16 v[130:131], v14 offset:41984
  ds_read_b128 v[136:139], v12 offset:32768
  v_mfma_f32_32x32x16_bf16 v[96:111], v[148:151], v[152:155], v[96:111]
  ds_read_b64_tr_b16 v[132:133], v15 offset:40960
  ds_read_b64_tr_b16 v[134:135], v15 offset:41984
  ds_read_b128 v[140:143], v12 offset:36864
  v_mfma_f32_32x32x16_bf16 v[80:95], v[144:147], v[156:159], v[80:95]
  v_mfma_f32_32x32x16_bf16 v[112:127], v[148:151], v[156:159], v[112:127]
  s_waitcnt lgkmcnt(0)
  v_mfma_f32_32x32x16_bf16 v[64:79], v[128:131], v[136:139], v[64:79]
  ds_read_b64_tr_b16 v[144:145], v14 offset:45056
  ds_read_b64_tr_b16 v[146:147], v14 offset:46080
  ds_read_b128 v[152:155], v13 offset:32768
  v_mfma_f32_32x32x16_bf16 v[96:111], v[132:135], v[136:139], v[96:111]
  ds_read_b64_tr_b16 v[148:149], v15 offset:45056
  ds_read_b64_tr_b16 v[150:151], v15 offset:46080
  ds_read_b128 v[156:159], v13 offset:36864
  v_mfma_f32_32x32x16_bf16 v[80:95], v[128:131], v[140:143], v[80:95]
  v_mfma_f32_32x32x16_bf16 v[112:127], v[132:135], v[140:143], v[112:127]
  s_waitcnt vmcnt(0) lgkmcnt(0)
  s_barrier
  v_mfma_f32_32x32x16_bf16 v[64:79], v[144:147], v[152:155], v[64:79]
  ds_read_b64_tr_b16 v[128:129], v14 offset:0
  ds_read_b64_tr_b16 v[130:131], v14 offset:1024
  ds_read_b128 v[136:139], v10 offset:0
  v_mfma_f32_32x32x16_bf16 v[96:111], v[148:151], v[152:155], v[96:111]
  ds_read_b64_tr_b16 v[132:133], v15 offset:0
  ds_read_b64_tr_b16 v[134:135], v15 offset:1024
  ds_read_b128 v[140:143], v10 offset:4096
  v_mfma_f32_32x32x16_bf16 v[80:95], v[144:147], v[156:159], v[80:95]
  v_mfma_f32_32x32x16_bf16 v[112:127], v[148:151], v[156:159], v[112:127]
  s_waitcnt lgkmcnt(0)
  v_mfma_f32_32x32x16_bf16 v[64:79], v[128:131], v[136:139], v[64:79]
  ds_read_b64_tr_b16 v[144:145], v14 offset:4096
  ds_read_b64_tr_b16 v[146:147], v14 offset:5120
  ds_read_b128 v[152:155], v11 offset:0
  v_mfma_f32_32x32x16_bf16 v[96:111], v[132:135], v[136:139], v[96:111]
  ds_read_b64_tr_b16 v[148:149], v15 offset:4096
  ds_read_b64_tr_b16 v[150:151], v15 offset:5120
  ds_read_b128 v[156:159], v11 offset:4096
  v_mfma_f32_32x32x16_bf16 v[80:95], v[128:131], v[140:143], v[80:95]
  v_mfma_f32_32x32x16_bf16 v[112:127], v[132:135], v[140:143], v[112:127]
  s_waitcnt lgkmcnt(0)
  v_mfma_f32_32x32x16_bf16 v[64:79], v[144:147], v[152:155], v[64:79]
  ds_read_b64_tr_b16 v[128:129], v14 offset:8192
  ds_read_b64_tr_b16 v[130:131], v14 offset:9216
  ds_read_b128 v[136:139], v12 offset:0
  v_mfma_f32_32x32x16_bf16 v[96:111], v[148:151], v[152:155], v[96:111]
  ds_read_b64_tr_b16 v[132:133], v15 offset:8192
  ds_read_b64_tr_b16 v[134:135], v15 offset:9216
  ds_read_b128 v[140:143], v12 offset:4096
  v_mfma_f32_32x32x16_bf16 v[80:95], v[144:147], v[156:159], v[80:95]
  v_mfma_f32_32x32x16_bf16 v[112:127], v[148:151], v[156:159], v[112:127]
  s_waitcnt lgkmcnt(0)
  v_mfma_f32_32x32x16_bf16 v[64:79], v[128:131], v[136:139], v[64:79]
  ds_read_b64_tr_b16 v[144:145], v14 offset:12288
  ds_read_b64_tr_b16 v[146:147], v14 offset:13312
  ds_read_b128 v[152:155], v13 offset:0
  v_mfma_f32_32x32x16_bf16 v[96:111], v[132:135], v[136:139], v[96:111]
  ds_read_b64_tr_b16 v[148:149], v15 offset:12288
  ds_read_b64_tr_b16 v[150:151], v15 offset:13312
  ds_read_b128 v[156:159], v13 offset:4096
  v_mfma_f32_32x32x16_bf16 v[80:95], v[128:131], v[140:143], v[80:95]
  v_mfma_f32_32x32x16_bf16 v[112:127], v[132:135], v[140:143], v[112:127]
  s_waitcnt lgkmcnt(0)
  v_mfma_f32_32x32x16_bf16 v[64:79], v[144:147], v[152:155], v[64:79]
  v_mfma_f32_32x32x16_bf16 v[96:111], v[148:151], v[152:155], v[96:111]
  v_mfma_f32_32x32x16_bf16 v[80:95], v[144:147], v[156:159], v[80:95]
  v_mfma_f32_32x32x16_bf16 v[112:127], v[148:151], v[156:159], v[112:127]
  s_setprio 2
  s_cmp_eq_u32 s21, 13
  s_cselect_b32 s27, s22, 0
  s_cmp_eq_u32 s27, 1
  s_cbranch_scc1 gend_9
  s_mov_b32 s34, 0xbdd2d3e8
  s_mov_b32 s35, 0xbdd2d3e8
  v_mov_b32 v20, 0xc0135761
  v_mov_b32 v21, 0xc0135761
  s_nop 7
.p2align 3
  v_pk_mul_f32 v[128:129], v[64:65], v[64:65]
  v_pk_mul_f32 v[136:137], v[68:69], v[68:69]
  v_pk_mul_f32 v[130:131], v[66:67], v[66:67]
  v_pk_mul_f32 v[138:139], v[70:71], v[70:71]
  v_pk_fma_f32 v[128:129], v[128:129], s[34:35], v[20:21]
  v_pk_fma_f32 v[136:137], v[136:137], s[34:35], v[20:21]
  v_pk_fma_f32 v[130:131], v[130:131], s[34:35], v[20:21]
  v_pk_fma_f32 v[138:139], v[138:139], s[34:35], v[20:21]
  v_pk_mul_f32 v[128:129], v[128:129], v[64:65]
  v_pk_mul_f32 v[136:137], v[136:137], v[68:69]
  v_pk_mul_f32 v[130:131], v[130:131], v[66:67]
  v_pk_mul_f32 v[138:139], v[138:139], v[70:71]
  v_exp_f32 v128, v128
  v_exp_f32 v136, v136
  v_exp_f32 v129, v129
  v_exp_f32 v137, v137
  v_exp_f32 v130, v130
  v_exp_f32 v138, v138
  v_exp_f32 v131, v131
  v_exp_f32 v139, v139
  v_pk_add_f32 v[128:129], v[128:129], 1.0 op_sel_hi:[1,0]
  v_pk_add_f32 v[136:137], v[136:137], 1.0 op_sel_hi:[1,0]
  v_pk_add_f32 v[130:131], v[130:131], 1.0 op_sel_hi:[1,0]
  v_pk_add_f32 v[138:139], v[138:139], 1.0 op_sel_hi:[1,0]
  v_rcp_f32 v128, v128
  v_rcp_f32 v136, v136
  v_rcp_f32 v129, v129
  v_rcp_f32 v137, v137
  v_rcp_f32 v130, v130
  v_rcp_f32 v138, v138
  v_rcp_f32 v131, v131
  v_rcp_f32 v139, v139
  v_pk_mul_f32 v[128:129], v[128:129], v[64:65]
  v_pk_mul_f32 v[136:137], v[136:137], v[68:69]
  v_pk_mul_f32 v[130:131], v[130:131], v[66:67]
  v_pk_mul_f32 v[138:139], v[138:139], v[70:71]
  v_cvt_pk_bf16_f32 v176, v128, v129
  v_cvt_pk_bf16_f32 v178, v136, v137
  v_cvt_pk_bf16_f32 v177, v130, v131
  v_cvt_pk_bf16_f32 v179, v138, v139
  buffer_store_dwordx4 v[176:179], v30, s[12:15], s32 offen offset:0 sc1
  v_pk_mul_f32 v[128:129], v[72:73], v[72:73]
  v_pk_mul_f32 v[136:137], v[76:77], v[76:77]
  v_pk_mul_f32 v[130:131], v[74:75], v[74:75]
  v_pk_mul_f32 v[138:139], v[78:79], v[78:79]
  v_pk_fma_f32 v[128:129], v[128:129], s[34:35], v[20:21]
  v_pk_fma_f32 v[136:137], v[136:137], s[34:35], v[20:21]
  v_pk_fma_f32 v[130:131], v[130:131], s[34:35], v[20:21]
  v_pk_fma_f32 v[138:139], v[138:139], s[34:35], v[20:21]
  v_pk_mul_f32 v[128:129], v[128:129], v[72:73]
  v_pk_mul_f32 v[136:137], v[136:137], v[76:77]
  v_pk_mul_f32 v[130:131], v[130:131], v[74:75]
  v_pk_mul_f32 v[138:139], v[138:139], v[78:79]
  v_exp_f32 v128, v128
  v_exp_f32 v136, v136
  v_exp_f32 v129, v129
  v_exp_f32 v137, v137
  v_exp_f32 v130, v130
  v_exp_f32 v138, v138
  v_exp_f32 v131, v131
  v_exp_f32 v139, v139
  v_pk_add_f32 v[128:129], v[128:129], 1.0 op_sel_hi:[1,0]
  v_pk_add_f32 v[136:137], v[136:137], 1.0 op_sel_hi:[1,0]
  v_pk_add_f32 v[130:131], v[130:131], 1.0 op_sel_hi:[1,0]
  v_pk_add_f32 v[138:139], v[138:139], 1.0 op_sel_hi:[1,0]
  v_rcp_f32 v128, v128
  v_rcp_f32 v136, v136
  v_rcp_f32 v129, v129
  v_rcp_f32 v137, v137
  v_rcp_f32 v130, v130
  v_rcp_f32 v138, v138
  v_rcp_f32 v131, v131
  v_rcp_f32 v139, v139
  v_pk_mul_f32 v[128:129], v[128:129], v[72:73]
  v_pk_mul_f32 v[136:137], v[136:137], v[76:77]
  v_pk_mul_f32 v[130:131], v[130:131], v[74:75]
  v_pk_mul_f32 v[138:139], v[138:139], v[78:79]
  v_cvt_pk_bf16_f32 v180, v128, v129
  v_cvt_pk_bf16_f32 v182, v136, v137
  v_cvt_pk_bf16_f32 v181, v130, v131
  v_cvt_pk_bf16_f32 v183, v138, v139
  buffer_store_dwordx4 v[180:183], v30, s[12:15], s32 offen offset:512 sc1
  v_pk_mul_f32 v[128:129], v[96:97], v[96:97]
  v_pk_mul_f32 v[136:137], v[100:101], v[100:101]
  v_pk_mul_f32 v[130:131], v[98:99], v[98:99]
  v_pk_mul_f32 v[138:139], v[102:103], v[102:103]
  v_pk_fma_f32 v[128:129], v[128:129], s[34:35], v[20:21]
  v_pk_fma_f32 v[136:137], v[136:137], s[34:35], v[20:21]
  v_pk_fma_f32 v[130:131], v[130:131], s[34:35], v[20:21]
  v_pk_fma_f32 v[138:139], v[138:139], s[34:35], v[20:21]
  v_pk_mul_f32 v[128:129], v[128:129], v[96:97]
  v_pk_mul_f32 v[136:137], v[136:137], v[100:101]
  v_pk_mul_f32 v[130:131], v[130:131], v[98:99]
  v_pk_mul_f32 v[138:139], v[138:139], v[102:103]
  v_exp_f32 v128, v128
  v_exp_f32 v136, v136
  v_exp_f32 v129, v129
  v_exp_f32 v137, v137
  v_exp_f32 v130, v130
  v_exp_f32 v138, v138
  v_exp_f32 v131, v131
  v_exp_f32 v139, v139
  v_pk_add_f32 v[128:129], v[128:129], 1.0 op_sel_hi:[1,0]
  v_pk_add_f32 v[136:137], v[136:137], 1.0 op_sel_hi:[1,0]
  v_pk_add_f32 v[130:131], v[130:131], 1.0 op_sel_hi:[1,0]
  v_pk_add_f32 v[138:139], v[138:139], 1.0 op_sel_hi:[1,0]
  v_rcp_f32 v128, v128
  v_rcp_f32 v136, v136
  v_rcp_f32 v129, v129
  v_rcp_f32 v137, v137
  v_rcp_f32 v130, v130
  v_rcp_f32 v138, v138
  v_rcp_f32 v131, v131
  v_rcp_f32 v139, v139
  v_pk_mul_f32 v[128:129], v[128:129], v[96:97]
  v_pk_mul_f32 v[136:137], v[136:137], v[100:101]
  v_pk_mul_f32 v[130:131], v[130:131], v[98:99]
  v_pk_mul_f32 v[138:139], v[138:139], v[102:103]
  v_cvt_pk_bf16_f32 v184, v128, v129
  v_cvt_pk_bf16_f32 v186, v136, v137
  v_cvt_pk_bf16_f32 v185, v130, v131
  v_cvt_pk_bf16_f32 v187, v138, v139
  buffer_store_dwordx4 v[184:187], v30, s[12:15], s33 offen offset:0 sc1
  v_pk_mul_f32 v[128:129], v[104:105], v[104:105]
  v_pk_mul_f32 v[136:137], v[108:109], v[108:109]
  v_pk_mul_f32 v[130:131], v[106:107], v[106:107]
  v_pk_mul_f32 v[138:139], v[110:111], v[110:111]
  v_pk_fma_f32 v[128:129], v[128:129], s[34:35], v[20:21]
  v_pk_fma_f32 v[136:137], v[136:137], s[34:35], v[20:21]
  v_pk_fma_f32 v[130:131], v[130:131], s[34:35], v[20:21]
  v_pk_fma_f32 v[138:139], v[138:139], s[34:35], v[20:21]
  v_pk_mul_f32 v[128:129], v[128:129], v[104:105]
  v_pk_mul_f32 v[136:137], v[136:137], v[108:109]
  v_pk_mul_f32 v[130:131], v[130:131], v[106:107]
  v_pk_mul_f32 v[138:139], v[138:139], v[110:111]
  v_exp_f32 v128, v128
  v_exp_f32 v136, v136
  v_exp_f32 v129, v129
  v_exp_f32 v137, v137
  v_exp_f32 v130, v130
  v_exp_f32 v138, v138
  v_exp_f32 v131, v131
  v_exp_f32 v139, v139
  v_pk_add_f32 v[128:129], v[128:129], 1.0 op_sel_hi:[1,0]
  v_pk_add_f32 v[136:137], v[136:137], 1.0 op_sel_hi:[1,0]
  v_pk_add_f32 v[130:131], v[130:131], 1.0 op_sel_hi:[1,0]
  v_pk_add_f32 v[138:139], v[138:139], 1.0 op_sel_hi:[1,0]
  v_rcp_f32 v128, v128
  v_rcp_f32 v136, v136
  v_rcp_f32 v129, v129
  v_rcp_f32 v137, v137
  v_rcp_f32 v130, v130
  v_rcp_f32 v138, v138
  v_rcp_f32 v131, v131
  v_rcp_f32 v139, v139
  v_pk_mul_f32 v[128:129], v[128:129], v[104:105]
  v_pk_mul_f32 v[136:137], v[136:137], v[108:109]
  v_pk_mul_f32 v[130:131], v[130:131], v[106:107]
  v_pk_mul_f32 v[138:139], v[138:139], v[110:111]
  v_cvt_pk_bf16_f32 v188, v128, v129
  v_cvt_pk_bf16_f32 v190, v136, v137
  v_cvt_pk_bf16_f32 v189, v130, v131
  v_cvt_pk_bf16_f32 v191, v138, v139
  buffer_store_dwordx4 v[188:191], v30, s[12:15], s33 offen offset:512 sc1
  v_pk_mul_f32 v[128:129], v[80:81], v[80:81]
  v_pk_mul_f32 v[136:137], v[84:85], v[84:85]
  v_pk_mul_f32 v[130:131], v[82:83], v[82:83]
  v_pk_mul_f32 v[138:139], v[86:87], v[86:87]
  v_pk_fma_f32 v[128:129], v[128:129], s[34:35], v[20:21]
  v_pk_fma_f32 v[136:137], v[136:137], s[34:35], v[20:21]
  v_pk_fma_f32 v[130:131], v[130:131], s[34:35], v[20:21]
  v_pk_fma_f32 v[138:139], v[138:139], s[34:35], v[20:21]
  v_pk_mul_f32 v[128:129], v[128:129], v[80:81]
  v_pk_mul_f32 v[136:137], v[136:137], v[84:85]
  v_pk_mul_f32 v[130:131], v[130:131], v[82:83]
  v_pk_mul_f32 v[138:139], v[138:139], v[86:87]
  v_exp_f32 v128, v128
  v_exp_f32 v136, v136
  v_exp_f32 v129, v129
  v_exp_f32 v137, v137
  v_exp_f32 v130, v130
  v_exp_f32 v138, v138
  v_exp_f32 v131, v131
  v_exp_f32 v139, v139
  v_pk_add_f32 v[128:129], v[128:129], 1.0 op_sel_hi:[1,0]
  v_pk_add_f32 v[136:137], v[136:137], 1.0 op_sel_hi:[1,0]
  v_pk_add_f32 v[130:131], v[130:131], 1.0 op_sel_hi:[1,0]
  v_pk_add_f32 v[138:139], v[138:139], 1.0 op_sel_hi:[1,0]
  v_rcp_f32 v128, v128
  v_rcp_f32 v136, v136
  v_rcp_f32 v129, v129
  v_rcp_f32 v137, v137
  v_rcp_f32 v130, v130
  v_rcp_f32 v138, v138
  v_rcp_f32 v131, v131
  v_rcp_f32 v139, v139
  v_pk_mul_f32 v[128:129], v[128:129], v[80:81]
  v_pk_mul_f32 v[136:137], v[136:137], v[84:85]
  v_pk_mul_f32 v[130:131], v[130:131], v[82:83]
  v_pk_mul_f32 v[138:139], v[138:139], v[86:87]
  v_cvt_pk_bf16_f32 v192, v128, v129
  v_cvt_pk_bf16_f32 v194, v136, v137
  v_cvt_pk_bf16_f32 v193, v130, v131
  v_cvt_pk_bf16_f32 v195, v138, v139
  buffer_store_dwordx4 v[192:195], v30, s[12:15], s32 offen offset:2048 sc1
  v_pk_mul_f32 v[128:129], v[88:89], v[88:89]
  v_pk_mul_f32 v[136:137], v[92:93], v[92:93]
  v_pk_mul_f32 v[130:131], v[90:91], v[90:91]
  v_pk_mul_f32 v[138:139], v[94:95], v[94:95]
  v_pk_fma_f32 v[128:129], v[128:129], s[34:35], v[20:21]
  v_pk_fma_f32 v[136:137], v[136:137], s[34:35], v[20:21]
  v_pk_fma_f32 v[130:131], v[130:131], s[34:35], v[20:21]
  v_pk_fma_f32 v[138:139], v[138:139], s[34:35], v[20:21]
  v_pk_mul_f32 v[128:129], v[128:129], v[88:89]
  v_pk_mul_f32 v[136:137], v[136:137], v[92:93]
  v_pk_mul_f32 v[130:131], v[130:131], v[90:91]
  v_pk_mul_f32 v[138:139], v[138:139], v[94:95]
  v_exp_f32 v128, v128
  v_exp_f32 v136, v136
  v_exp_f32 v129, v129
  v_exp_f32 v137, v137
  v_exp_f32 v130, v130
  v_exp_f32 v138, v138
  v_exp_f32 v131, v131
  v_exp_f32 v139, v139
  v_pk_add_f32 v[128:129], v[128:129], 1.0 op_sel_hi:[1,0]
  v_pk_add_f32 v[136:137], v[136:137], 1.0 op_sel_hi:[1,0]
  v_pk_add_f32 v[130:131], v[130:131], 1.0 op_sel_hi:[1,0]
  v_pk_add_f32 v[138:139], v[138:139], 1.0 op_sel_hi:[1,0]
  v_rcp_f32 v128, v128
  v_rcp_f32 v136, v136
  v_rcp_f32 v129, v129
  v_rcp_f32 v137, v137
  v_rcp_f32 v130, v130
  v_rcp_f32 v138, v138
  v_rcp_f32 v131, v131
  v_rcp_f32 v139, v139
  v_pk_mul_f32 v[128:129], v[128:129], v[88:89]
  v_pk_mul_f32 v[136:137], v[136:137], v[92:93]
  v_pk_mul_f32 v[130:131], v[130:131], v[90:91]
  v_pk_mul_f32 v[138:139], v[138:139], v[94:95]
  v_cvt_pk_bf16_f32 v196, v128, v129
  v_cvt_pk_bf16_f32 v198, v136, v137
  v_cvt_pk_bf16_f32 v197, v130, v131
  v_cvt_pk_bf16_f32 v199, v138, v139
  buffer_store_dwordx4 v[196:199], v30, s[12:15], s32 offen offset:2560 sc1
  v_pk_mul_f32 v[128:129], v[112:113], v[112:113]
  v_pk_mul_f32 v[136:137], v[116:117], v[116:117]
  v_pk_mul_f32 v[130:131], v[114:115], v[114:115]
  v_pk_mul_f32 v[138:139], v[118:119], v[118:119]
  v_pk_fma_f32 v[128:129], v[128:129], s[34:35], v[20:21]
  v_pk_fma_f32 v[136:137], v[136:137], s[34:35], v[20:21]
  v_pk_fma_f32 v[130:131], v[130:131], s[34:35], v[20:21]
  v_pk_fma_f32 v[138:139], v[138:139], s[34:35], v[20:21]
  v_pk_mul_f32 v[128:129], v[128:129], v[112:113]
  v_pk_mul_f32 v[136:137], v[136:137], v[116:117]
  v_pk_mul_f32 v[130:131], v[130:131], v[114:115]
  v_pk_mul_f32 v[138:139], v[138:139], v[118:119]
  v_exp_f32 v128, v128
  v_exp_f32 v136, v136
  v_exp_f32 v129, v129
  v_exp_f32 v137, v137
  v_exp_f32 v130, v130
  v_exp_f32 v138, v138
  v_exp_f32 v131, v131
  v_exp_f32 v139, v139
  v_pk_add_f32 v[128:129], v[128:129], 1.0 op_sel_hi:[1,0]
  v_pk_add_f32 v[136:137], v[136:137], 1.0 op_sel_hi:[1,0]
  v_pk_add_f32 v[130:131], v[130:131], 1.0 op_sel_hi:[1,0]
  v_pk_add_f32 v[138:139], v[138:139], 1.0 op_sel_hi:[1,0]
  v_rcp_f32 v128, v128
  v_rcp_f32 v136, v136
  v_rcp_f32 v129, v129
  v_rcp_f32 v137, v137
  v_rcp_f32 v130, v130
  v_rcp_f32 v138, v138
  v_rcp_f32 v131, v131
  v_rcp_f32 v139, v139
  v_pk_mul_f32 v[128:129], v[128:129], v[112:113]
  v_pk_mul_f32 v[136:137], v[136:137], v[116:117]
  v_pk_mul_f32 v[130:131], v[130:131], v[114:115]
  v_pk_mul_f32 v[138:139], v[138:139], v[118:119]
  v_cvt_pk_bf16_f32 v200, v128, v129
  v_cvt_pk_bf16_f32 v202, v136, v137
  v_cvt_pk_bf16_f32 v201, v130, v131
  v_cvt_pk_bf16_f32 v203, v138, v139
  buffer_store_dwordx4 v[200:203], v30, s[12:15], s33 offen offset:2048 sc1
  v_pk_mul_f32 v[128:129], v[120:121], v[120:121]
  v_pk_mul_f32 v[136:137], v[124:125], v[124:125]
  v_pk_mul_f32 v[130:131], v[122:123], v[122:123]
  v_pk_mul_f32 v[138:139], v[126:127], v[126:127]
  v_pk_fma_f32 v[128:129], v[128:129], s[34:35], v[20:21]
  v_pk_fma_f32 v[136:137], v[136:137], s[34:35], v[20:21]
  v_pk_fma_f32 v[130:131], v[130:131], s[34:35], v[20:21]
  v_pk_fma_f32 v[138:139], v[138:139], s[34:35], v[20:21]
  v_pk_mul_f32 v[128:129], v[128:129], v[120:121]
  v_pk_mul_f32 v[136:137], v[136:137], v[124:125]
  v_pk_mul_f32 v[130:131], v[130:131], v[122:123]
  v_pk_mul_f32 v[138:139], v[138:139], v[126:127]
  v_exp_f32 v128, v128
  v_exp_f32 v136, v136
  v_exp_f32 v129, v129
  v_exp_f32 v137, v137
  v_exp_f32 v130, v130
  v_exp_f32 v138, v138
  v_exp_f32 v131, v131
  v_exp_f32 v139, v139
  v_pk_add_f32 v[128:129], v[128:129], 1.0 op_sel_hi:[1,0]
  v_pk_add_f32 v[136:137], v[136:137], 1.0 op_sel_hi:[1,0]
  v_pk_add_f32 v[130:131], v[130:131], 1.0 op_sel_hi:[1,0]
  v_pk_add_f32 v[138:139], v[138:139], 1.0 op_sel_hi:[1,0]
  v_rcp_f32 v128, v128
  v_rcp_f32 v136, v136
  v_rcp_f32 v129, v129
  v_rcp_f32 v137, v137
  v_rcp_f32 v130, v130
  v_rcp_f32 v138, v138
  v_rcp_f32 v131, v131
  v_rcp_f32 v139, v139
  v_pk_mul_f32 v[128:129], v[128:129], v[120:121]
  v_pk_mul_f32 v[136:137], v[136:137], v[124:125]
  v_pk_mul_f32 v[130:131], v[130:131], v[122:123]
  v_pk_mul_f32 v[138:139], v[138:139], v[126:127]
  v_cvt_pk_bf16_f32 v204, v128, v129
  v_cvt_pk_bf16_f32 v206, v136, v137
  v_cvt_pk_bf16_f32 v205, v130, v131
  v_cvt_pk_bf16_f32 v207, v138, v139
  buffer_store_dwordx4 v[204:207], v30, s[12:15], s33 offen offset:2560 sc1
gend_9:
  s_endpgm
help_2:
  s_setprio 1
  s_mul_i32 s18, s22, 28
  s_add_u32 s18, s18, s23
  s_sub_u32 s19, s3, 4
  s_lshl_b32 s72, s18, 1
  s_lshr_b32 s20, s19, 1
  s_add_u32 s20, s20, s72
  s_add_u32 s75, s72, 1
  s_movk_i32 s78, 540
  s_mov_b32 s35, 1
  s_branch kgen_3
spare_4:
  s_lshl_b32 s18, s22, 2
  s_add_u32 s18, s18, s23
  s_sub_u32 s18, s18, 28
  s_mul_i32 s72, s18, 3
  s_add_u32 s72, s72, 448
  s_add_u32 s75, s72, 1
  s_add_u32 s78, s72, 2
  s_mul_i32 s20, s18, 6
  s_add_u32 s20, s20, s3
  s_add_u32 s20, s20, 448
  s_mov_b32 s19, s3
  s_lshl_b32 s33, s18, 1
  s_add_u32 s33, s33, s3
  s_sub_u32 s33, s33, 6
  s_lshl_b32 s33, s33, 1
  s_add_u32 s18, s18, 224
  s_mov_b32 s35, 0
  s_cmp_lt_u32 s3, 6
  s_cbranch_scc1 kgen_3
  s_mul_i32 s25, s3, 16048
  s_waitcnt lgkmcnt(0)
  s_mov_b32 s12, s70
  s_mov_b32 s13, s71
  s_mov_b32 s14, 0x10000000
  s_mov_b32 s15, 0x00020000
gate_12:
  s_mov_b32 s4, s36
  s_mov_b32 s5, s37
  s_mov_b32 s6, 0x280000
  s_mov_b32 s7, 0x00020000
  s_mov_b32 s8, s64
  s_mov_b32 s9, s65
  s_mov_b32 s10, 0x500
  s_mov_b32 s11, 0x00020000
  v_lshrrev_b32 v1, 3, v0
  v_and_b32 v2, 7, v0
  v_mul_u32_u24 v3, 1280, v1
  v_lshl_add_u32 v3, v2, 4, v3
  v_lshlrev_b32 v7, 4, v2
  s_mul_i32 s24, s33, 20480
  s_add_u32 s23, s24, 10240
  buffer_load_dwordx4 v[144:147], v7, s[8:11], 0 offen offset:0
  buffer_load_dwordx4 v[148:151], v7, s[8:11], 0 offen offset:128
  buffer_load_dwordx4 v[152:155], v7, s[8:11], 0 offen offset:256
  buffer_load_dwordx4 v[156:159], v7, s[8:11], 0 offen offset:384
  buffer_load_dwordx4 v[160:163], v7, s[8:11], 0 offen offset:512
  buffer_load_dwordx4 v[164:167], v7, s[8:11], 0 offen offset:640
  buffer_load_dwordx4 v[168:171], v7, s[8:11], 0 offen offset:768
  buffer_load_dwordx4 v[172:175], v7, s[8:11], 0 offen offset:896
  buffer_load_dwordx4 v[176:179], v7, s[8:11], 0 offen offset:1024
  buffer_load_dwordx4 v[180:183], v7, s[8:11], 0 offen offset:1152
  buffer_load_dwordx4 v[64:67], v3, s[4:7], s24 offen offset:0
  buffer_load_dwordx4 v[68:71], v3, s[4:7], s24 offen offset:128
  buffer_load_dwordx4 v[72:75], v3, s[4:7], s24 offen offset:256
  buffer_load_dwordx4 v[76:79], v3, s[4:7], s24 offen offset:384
  buffer_load_dwordx4 v[80:83], v3, s[4:7], s24 offen offset:512
  buffer_load_dwordx4 v[84:87], v3, s[4:7], s24 offen offset:640
  buffer_load_dwordx4 v[88:91], v3, s[4:7], s24 offen offset:768
  buffer_load_dwordx4 v[92:95], v3, s[4:7], s24 offen offset:896
  buffer_load_dwordx4 v[96:99], v3, s[4:7], s24 offen offset:1024
  buffer_load_dwordx4 v[100:103], v3, s[4:7], s24 offen offset:1152
  buffer_load_dwordx4 v[104:107], v3, s[4:7], s23 offen offset:0
  buffer_load_dwordx4 v[108:111], v3, s[4:7], s23 offen offset:128
  buffer_load_dwordx4 v[112:115], v3, s[4:7], s23 offen offset:256
  buffer_load_dwordx4 v[116:119], v3, s[4:7], s23 offen offset:384
  buffer_load_dwordx4 v[120:123], v3, s[4:7], s23 offen offset:512
  buffer_load_dwordx4 v[124:127], v3, s[4:7], s23 offen offset:640
  buffer_load_dwordx4 v[128:131], v3, s[4:7], s23 offen offset:768
  buffer_load_dwordx4 v[132:135], v3, s[4:7], s23 offen offset:896
  buffer_load_dwordx4 v[136:139], v3, s[4:7], s23 offen offset:1024
  buffer_load_dwordx4 v[140:143], v3, s[4:7], s23 offen offset:1152
  s_waitcnt vmcnt(10)
  v_mov_b32 v40, 0
  v_mov_b32 v41, 0
  v_mov_b32 v42, 0
  v_mov_b32 v43, 0
  v_mov_b32 v44, 0
  v_mov_b32 v45, 0
  v_mov_b32 v46, 0
  v_mov_b32 v47, 0
  v_dot2c_f32_bf16 v40, v64, v144
  v_dot2c_f32_bf16 v41, v65, v145
  v_dot2c_f32_bf16 v42, v66, v146
  v_dot2c_f32_bf16 v43, v67, v147
  v_dot2c_f32_bf16 v40, v68, v148
  v_dot2c_f32_bf16 v41, v69, v149
  v_dot2c_f32_bf16 v42, v70, v150
  v_dot2c_f32_bf16 v43, v71, v151
  v_dot2c_f32_bf16 v40, v72, v152
  v_dot2c_f32_bf16 v41, v73, v153
  v_dot2c_f32_bf16 v42, v74, v154
  v_dot2c_f32_bf16 v43, v75, v155
  v_dot2c_f32_bf16 v40, v76, v156
  v_dot2c_f32_bf16 v41, v77, v157
  v_dot2c_f32_bf16 v42, v78, v158
  v_dot2c_f32_bf16 v43, v79, v159
  v_dot2c_f32_bf16 v40, v80, v160
  v_dot2c_f32_bf16 v41, v81, v161
  v_dot2c_f32_bf16 v42, v82, v162
  v_dot2c_f32_bf16 v43, v83, v163
  v_dot2c_f32_bf16 v40, v84, v164
  v_dot2c_f32_bf16 v41, v85, v165
  v_dot2c_f32_bf16 v42, v86, v166
  v_dot2c_f32_bf16 v43, v87, v167
  v_dot2c_f32_bf16 v40, v88, v168
  v_dot2c_f32_bf16 v41, v89, v169
  v_dot2c_f32_bf16 v42, v90, v170
  v_dot2c_f32_bf16 v43, v91, v171
  v_dot2c_f32_bf16 v40, v92, v172
  v_dot2c_f32_bf16 v41, v93, v173
  v_dot2c_f32_bf16 v42, v94, v174
  v_dot2c_f32_bf16 v43, v95, v175
  v_dot2c_f32_bf16 v40, v96, v176
  v_dot2c_f32_bf16 v41, v97, v177
  v_dot2c_f32_bf16 v42, v98, v178
  v_dot2c_f32_bf16 v43, v99, v179
  v_dot2c_f32_bf16 v40, v100, v180
  v_dot2c_f32_bf16 v41, v101, v181
  v_dot2c_f32_bf16 v42, v102, v182
  v_dot2c_f32_bf16 v43, v103, v183
  s_waitcnt vmcnt(0)
  v_dot2c_f32_bf16 v44, v104, v144
  v_dot2c_f32_bf16 v45, v105, v145
  v_dot2c_f32_bf16 v46, v106, v146
  v_dot2c_f32_bf16 v47, v107, v147
  v_dot2c_f32_bf16 v44, v108, v148
  v_dot2c_f32_bf16 v45, v109, v149
  v_dot2c_f32_bf16 v46, v110, v150
  v_dot2c_f32_bf16 v47, v111, v151
  v_dot2c_f32_bf16 v44, v112, v152
  v_dot2c_f32_bf16 v45, v113, v153
  v_dot2c_f32_bf16 v46, v114, v154
  v_dot2c_f32_bf16 v47, v115, v155
  v_dot2c_f32_bf16 v44, v116, v156
  v_dot2c_f32_bf16 v45, v117, v157
  v_dot2c_f32_bf16 v46, v118, v158
  v_dot2c_f32_bf16 v47, v119, v159
  v_dot2c_f32_bf16 v44, v120, v160
  v_dot2c_f32_bf16 v45, v121, v161
  v_dot2c_f32_bf16 v46, v122, v162
  v_dot2c_f32_bf16 v47, v123, v163
  v_dot2c_f32_bf16 v44, v124, v164
  v_dot2c_f32_bf16 v45, v125, v165
  v_dot2c_f32_bf16 v46, v126, v166
  v_dot2c_f32_bf16 v47, v127, v167
  v_dot2c_f32_bf16 v44, v128, v168
  v_dot2c_f32_bf16 v45, v129, v169
  v_dot2c_f32_bf16 v46, v130, v170
  v_dot2c_f32_bf16 v47, v131, v171
  v_dot2c_f32_bf16 v44, v132, v172
  v_dot2c_f32_bf16 v45, v133, v173
  v_dot2c_f32_bf16 v46, v134, v174
  v_dot2c_f32_bf16 v47, v135, v175
  v_dot2c_f32_bf16 v44, v136, v176
  v_dot2c_f32_bf16 v45, v137, v177
  v_dot2c_f32_bf16 v46, v138, v178
  v_dot2c_f32_bf16 v47, v139, v179
  v_dot2c_f32_bf16 v44, v140, v180
  v_dot2c_f32_bf16 v45, v141, v181
  v_dot2c_f32_bf16 v46, v142, v182
  v_dot2c_f32_bf16 v47, v143, v183
  s_nop 1
  v_add_f32 v40, v40, v41
  v_add_f32 v42, v42, v43
  v_add_f32 v40, v40, v42
  v_add_f32 v44, v44, v45
  v_add_f32 v46, v46, v47
  v_add_f32 v44, v44, v46
  s_nop 1
  v_add_f32_dpp v40, v40, v40 quad_perm:[1,0,3,2] row_mask:0xf bank_mask:0xf
  v_add_f32_dpp v44, v44, v44 quad_perm:[1,0,3,2] row_mask:0xf bank_mask:0xf
  s_nop 1
  v_add_f32_dpp v40, v40, v40 quad_perm:[2,3,0,1] row_mask:0xf bank_mask:0xf
  v_add_f32_dpp v44, v44, v44 quad_perm:[2,3,0,1] row_mask:0xf bank_mask:0xf
  s_nop 1
  v_add_f32_dpp v40, v40, v40 row_half_mirror row_mask:0xf bank_mask:0xf
  v_add_f32_dpp v44, v44, v44 row_half_mirror row_mask:0xf bank_mask:0xf
  v_mul_f32 v40, 0xbfb8aa3b, v40
  v_mul_f32 v44, 0xbfb8aa3b, v44
  v_exp_f32 v40, v40
  v_exp_f32 v44, v44
  s_lshl_b32 s24, s33, 6
  s_add_u32 s24, s24, 22020096
  v_add_f32 v40, 1.0, v40
  v_add_f32 v44, 1.0, v44
  v_rcp_f32 v40, v40
  v_rcp_f32 v44, v44
  v_lshlrev_b32 v61, 2, v1
  s_nop 0
  buffer_store_dword v40, v61, s[12:15], s24 offen
  buffer_store_dword v44, v61, s[12:15], s24 offen offset:32
  s_add_u32 s33, s33, 1
  s_bitcmp1_b32 s33, 0
  s_cbranch_scc1 gate_12
  s_branch misc_10
kgen_3:
  s_lshl_b32 s21, s20, 8
  v_lshl_add_u32 v1, v0, 2, s21
  s_lshl_b32 s22, s20, 1
  s_and_b32 s23, s22, 0xfffffffc
  s_waitcnt lgkmcnt(0)
  s_load_dword s24, s[50:51], s23
  s_load_dword s93, s[52:53], s23
  global_load_dword v2, v1, s[38:39]
  global_load_dword v3, v1, s[40:41]
  global_load_dword v4, v1, s[42:43]
  global_load_dword v5, v1, s[44:45]
  global_load_dword v6, v1, s[46:47]
  global_load_dword v7, v1, s[48:49]
  s_mov_b32 s12, s70
  s_mov_b32 s13, s71
  s_mov_b32 s14, 0x10000000
  s_mov_b32 s15, 0x00020000
  s_cmp_lg_u32 s35, 0
  s_cbranch_scc1 tw_13
  s_mov_b32 s4, s36
  s_mov_b32 s5, s37
  s_mov_b32 s6, 0x280000
  s_mov_b32 s7, 0x00020000
  s_mov_b32 s8, s56
  s_mov_b32 s9, s57
  s_mov_b32 s10, 0x21c000
  s_mov_b32 s11, 0x00020000
  s_mov_b32 s84, s60
  s_mov_b32 s85, s61
  s_mov_b32 s86, 0x21c000
  s_mov_b32 s87, 0x00020000
  s_lshr_b32 s26, s2, 3
  s_sub_u32 s26, s26, 28
  s_mul_i32 s26, s26, 6
  s_add_u32 s26, s26, s3
  s_mul_i32 s27, s26, 91
  s_add_u32 s27, s27, 0
  v_add_u32 v40, s27, v0
  s_and_b32 s28, s2, 7
  s_mul_i32 s27, s28, 44
  s_sub_u32 s27, 392, s27
  s_mul_i32 s28, s28, 56
  v_lshrrev_b32 v41, 5, v40
  v_mov_b32 v42, s27
  v_cmp_le_u32 vcc, 56, v41
  v_cndmask_b32 v42, 0, v42, vcc
  v_add3_u32 v41, v41, v42, s28
  v_mul_u32_u24 v42, 6554, v41
  v_lshrrev_b32 v42, 16, v42
  v_lshlrev_b32 v41, 7, v41
  v_mul_u32_u24 v42, 39680, v42
  v_add_u32 v41, v41, v42
  v_and_b32 v42, 31, v40
  v_mul_u32_u24 v42, 1280, v42
  v_add_u32 v41, v41, v42
  v_cmp_gt_u32 vcc, 2176, v40
  v_cndmask_b32 v41, -1, v41, vcc
  buffer_load_dword v245, v41, s[84:87], 0 offen
  s_mul_i32 s27, s26, 91
  s_add_u32 s27, s27, 64
  v_add_u32 v40, s27, v0
  s_and_b32 s28, s2, 7
  s_mul_i32 s27, s28, 44
  s_sub_u32 s27, 392, s27
  s_mul_i32 s28, s28, 56
  v_lshrrev_b32 v41, 5, v40
  v_mov_b32 v42, s27
  v_cmp_le_u32 vcc, 56, v41
  v_cndmask_b32 v42, 0, v42, vcc
  v_add3_u32 v41, v41, v42, s28
  v_mul_u32_u24 v42, 6554, v41
  v_lshrrev_b32 v42, 16, v42
  v_lshlrev_b32 v41, 7, v41
  v_mul_u32_u24 v42, 39680, v42
  v_add_u32 v41, v41, v42
  v_and_b32 v42, 31, v40
  v_mul_u32_u24 v42, 1280, v42
  v_add_u32 v41, v41, v42
  v_cmp_gt_u32 vcc, 27, v0
  v_cndmask_b32 v41, -1, v41, vcc
  v_cmp_gt_u32 vcc, 2176, v40
  v_cndmask_b32 v41, -1, v41, vcc
  buffer_load_dword v246, v41, s[84:87], 0 offen
tw_13:
  s_mul_i32 s25, s19, 16048
  s_add_u32 s25, s25, 0
  s_mov_b32 m0, s25
  v_and_b32 v11, 31, v0
  v_mul_u32_u24 v11, 272, v11
  v_lshrrev_b32 v12, 5, v0
  v_lshl_add_u32 v11, v12, 4, v11
  v_add_u32 v11, s25, v11
  v_and_b32 v10, 31, v0
  v_mul_u32_u24 v10, 544, v10
  v_sub_u32 v10, v11, v10
  v_add_u32 v10, 8432, v10
  s_and_b32 s22, s22, 2
  s_lshl_b32 s22, s22, 3
  s_mov_b32 s26, 0x3fb8aa3b
  s_mov_b32 s27, 0x32a57060
  s_mov_b32 s28, 0x3f317218
  s_mov_b32 s29, 0x3e22f983
  s_waitcnt lgkmcnt(0)
  s_lshr_b32 s24, s24, s22
  s_lshl_b32 s24, s24, 16
  s_lshr_b32 s93, s93, s22
  s_lshl_b32 s93, s93, 16
  v_mov_b32 v13, s24
  v_mul_f32 v14, s26, v13
  v_fma_f32 v15, v13, s26, -v14
  v_fma_f32 v15, v13, s27, v15
  v_exp_f32 v14, v14
  v_mul_f32 v15, s28, v15
  v_fma_f32 v14, v14, v15, v14
  v_cvt_pk_bf16_f32 v14, v14, v14
  v_lshlrev_b32 v13, 16, v14
  v_mov_b32 v96, 0
  v_mov_b32 v97, 0
  v_mov_b32 v98, 0
  v_mov_b32 v99, 0
  v_mov_b32 v100, 0
  v_mov_b32 v101, 0
  v_mov_b32 v102, 0
  v_mov_b32 v103, 0
  v_mov_b32 v104, 0
  v_mov_b32 v105, 0
  v_mov_b32 v106, 0
  v_mov_b32 v107, 0
  v_mov_b32 v108, 0
  v_mov_b32 v109, 0
  v_mov_b32 v110, 0
  v_mov_b32 v111, 0
  s_and_b32 s31, s3, s35
  s_lshl_b32 s30, s31, 4
  s_sub_u32 s30, 16, s30
  s_cmp_eq_u32 s31, 0
  s_cselect_b32 s93, s93, 0
  v_writelane_b32 v96, s93, 31
  s_cmp_lg_u32 s35, 0
  s_cbranch_scc1 tq_14
  s_waitcnt vmcnt(2)
  s_branch tr_15
tq_14:
  s_waitcnt vmcnt(0)
tr_15:
.p2align 3
kg_16:
  v_lshlrev_b32 v14, s30, v2
  v_lshlrev_b32 v15, s30, v3
  v_lshlrev_b32 v16, s30, v4
  v_lshlrev_b32 v17, s30, v5
  v_lshlrev_b32 v18, s30, v6
  v_lshlrev_b32 v19, s30, v7
  v_and_b32 v14, 0xffff0000, v14
  v_and_b32 v15, 0xffff0000, v15
  v_and_b32 v16, 0xffff0000, v16
  v_and_b32 v17, 0xffff0000, v17
  v_and_b32 v18, 0xffff0000, v18
  v_and_b32 v19, 0xffff0000, v19
  v_mul_f32 v14, v14, v13
  v_mul_f32 v15, v15, v13
  v_mul_f32 v16, v16, v13
  v_mul_f32 v17, v17, v13
  v_mul_f32 v14, s26, v14
  v_mul_f32 v15, s29, v15
  v_mul_f32 v34, 0x41000000, v14
  v_mul_f32 v35, 0x41000000, v15
  v_mul_f32 v36, 0x43800000, v14
  v_mul_f32 v37, 0x43800000, v15
  v_fract_f32 v15, v15
  v_fract_f32 v35, v35
  v_fract_f32 v37, v37
  v_exp_f32 v14, v14
  v_exp_f32 v34, v34
  v_exp_f32 v36, v36
  v_cos_f32 v20, v15
  v_sin_f32 v21, v15
  v_cos_f32 v22, v35
  v_sin_f32 v23, v35
  v_cos_f32 v24, v37
  v_sin_f32 v25, v37
  v_pk_mul_f32 v[32:33], v[18:19], v[16:17] op_sel:[0,0] op_sel_hi:[1,0]
  v_pk_fma_f32 v[32:33], v[18:19], v[16:17], v[32:33] op_sel:[1,1,0] op_sel_hi:[0,1,1] neg_lo:[0,1,0]
  v_pk_mul_f32 v[20:21], v[20:21], v[14:15] op_sel_hi:[1,0]
  v_pk_mul_f32 v[22:23], v[22:23], v[34:35] op_sel_hi:[1,0]
  v_pk_mul_f32 v[24:25], v[24:25], v[36:37] op_sel_hi:[1,0]
  v_pk_mul_f32 v[26:27], v[20:21], v[20:21] op_sel:[0,0] op_sel_hi:[1,0]
  v_pk_mul_f32 v[30:31], v[22:23], v[22:23] op_sel:[0,0] op_sel_hi:[1,0]
  v_pk_fma_f32 v[26:27], v[20:21], v[20:21], v[26:27] op_sel:[1,1,0] op_sel_hi:[0,1,1] neg_lo:[0,1,0]
  v_pk_fma_f32 v[30:31], v[22:23], v[22:23], v[30:31] op_sel:[1,1,0] op_sel_hi:[0,1,1] neg_lo:[0,1,0]
  v_pk_mul_f32 v[28:29], v[26:27], v[26:27] op_sel:[0,0] op_sel_hi:[1,0]
  v_pk_fma_f32 v[28:29], v[26:27], v[26:27], v[28:29] op_sel:[1,1,0] op_sel_hi:[0,1,1] neg_lo:[0,1,0]
.p2align 3
  v_cvt_pk_bf16_f32 v54, v32, -v33
  v_mov_b32 v38, 0x3f80
  v_cvt_pk_bf16_f32 v46, v22, v23
  ds_write_addtid_b32 v54 offset:0
  v_pk_mul_f32 v[62:63], v[32:33], v[24:25] op_sel:[0,0] op_sel_hi:[1,0]
  ds_write_addtid_b32 v38 offset:7344
  ds_write_addtid_b32 v46 offset:7616
  v_pk_mul_f32 v[56:57], v[32:33], v[20:21] op_sel:[0,0] op_sel_hi:[1,0]
  v_pk_fma_f32 v[62:63], v[32:33], v[24:25], v[62:63] op_sel:[1,1,0] op_sel_hi:[0,1,1] neg_lo:[0,1,0]
  v_cvt_pk_bf16_f32 v39, v30, v31
  v_pk_mul_f32 v[48:49], v[22:23], v[30:31] op_sel:[0,0] op_sel_hi:[1,0]
  v_pk_fma_f32 v[56:57], v[32:33], v[20:21], v[56:57] op_sel:[1,1,0] op_sel_hi:[0,1,1] neg_lo:[0,1,0]
  v_pk_fma_f32 v[48:49], v[22:23], v[30:31], v[48:49] op_sel:[1,1,0] op_sel_hi:[0,1,1] neg_lo:[0,1,0]
  v_cvt_pk_bf16_f32 v76, v62, -v63
  ds_write_addtid_b32 v39 offset:7888
  v_cvt_pk_bf16_f32 v60, v56, -v57
  v_pk_mul_f32 v[40:41], v[30:31], v[30:31] op_sel:[0,0] op_sel_hi:[1,0]
  v_cvt_pk_bf16_f32 v52, v48, v49
  ds_write_addtid_b32 v76 offset:2176
  ds_write_addtid_b32 v60 offset:272
  v_pk_fma_f32 v[40:41], v[30:31], v[30:31], v[40:41] op_sel:[1,1,0] op_sel_hi:[0,1,1] neg_lo:[0,1,0]
  ds_write_addtid_b32 v52 offset:8160
  v_pk_mul_f32 v[64:65], v[62:63], v[24:25] op_sel:[0,0] op_sel_hi:[1,0]
  v_pk_mul_f32 v[50:51], v[48:49], v[30:31] op_sel:[0,0] op_sel_hi:[1,0]
  v_pk_mul_f32 v[58:59], v[56:57], v[20:21] op_sel:[0,0] op_sel_hi:[1,0]
  v_cvt_pk_bf16_f32 v44, v40, v41
  v_pk_fma_f32 v[64:65], v[62:63], v[24:25], v[64:65] op_sel:[1,1,0] op_sel_hi:[0,1,1] neg_lo:[0,1,0]
  v_pk_fma_f32 v[50:51], v[48:49], v[30:31], v[50:51] op_sel:[1,1,0] op_sel_hi:[0,1,1] neg_lo:[0,1,0]
  v_pk_fma_f32 v[58:59], v[56:57], v[20:21], v[58:59] op_sel:[1,1,0] op_sel_hi:[0,1,1] neg_lo:[0,1,0]
  ds_write_addtid_b32 v44 offset:8432
  v_cvt_pk_bf16_f32 v77, v64, -v65
  v_pk_mul_f32 v[42:43], v[40:41], v[30:31] op_sel:[0,0] op_sel_hi:[1,0]
  v_cvt_pk_bf16_f32 v53, v50, v51
  v_cvt_pk_bf16_f32 v61, v58, -v59
  ds_write_addtid_b32 v77 offset:4624
  v_pk_fma_f32 v[42:43], v[40:41], v[30:31], v[42:43] op_sel:[1,1,0] op_sel_hi:[0,1,1] neg_lo:[0,1,0]
  ds_write_addtid_b32 v53 offset:8704
  ds_write_addtid_b32 v61 offset:544
  v_pk_mul_f32 v[48:49], v[50:51], v[30:31] op_sel:[0,0] op_sel_hi:[1,0]
  v_pk_mul_f32 v[66:67], v[64:65], v[24:25] op_sel:[0,0] op_sel_hi:[1,0]
  v_cvt_pk_bf16_f32 v45, v42, v43
  v_pk_mul_f32 v[56:57], v[58:59], v[20:21] op_sel:[0,0] op_sel_hi:[1,0]
  v_pk_fma_f32 v[48:49], v[50:51], v[30:31], v[48:49] op_sel:[1,1,0] op_sel_hi:[0,1,1] neg_lo:[0,1,0]
  v_pk_fma_f32 v[66:67], v[64:65], v[24:25], v[66:67] op_sel:[1,1,0] op_sel_hi:[0,1,1] neg_lo:[0,1,0]
  ds_write_addtid_b32 v45 offset:8976
  v_pk_fma_f32 v[56:57], v[58:59], v[20:21], v[56:57] op_sel:[1,1,0] op_sel_hi:[0,1,1] neg_lo:[0,1,0]
  v_pk_mul_f32 v[40:41], v[42:43], v[30:31] op_sel:[0,0] op_sel_hi:[1,0]
  v_cvt_pk_bf16_f32 v52, v48, v49
  v_cvt_pk_bf16_f32 v76, v66, -v67
  ds_write_addtid_b32 v52 offset:9248
  v_cvt_pk_bf16_f32 v60, v56, -v57
  v_pk_fma_f32 v[40:41], v[42:43], v[30:31], v[40:41] op_sel:[1,1,0] op_sel_hi:[0,1,1] neg_lo:[0,1,0]
  ds_write_addtid_b32 v76 offset:6528
  v_pk_mul_f32 v[50:51], v[48:49], v[30:31] op_sel:[0,0] op_sel_hi:[1,0]
  ds_write_addtid_b32 v60 offset:816
  v_cvt_pk_bf16_f32 v44, v40, v41
  v_pk_mul_f32 v[68:69], v[66:67], v[24:25] op_sel:[0,0] op_sel_hi:[1,0]
  v_pk_fma_f32 v[50:51], v[48:49], v[30:31], v[50:51] op_sel:[1,1,0] op_sel_hi:[0,1,1] neg_lo:[0,1,0]
  v_pk_mul_f32 v[58:59], v[56:57], v[20:21] op_sel:[0,0] op_sel_hi:[1,0]
  ds_write_addtid_b32 v44 offset:9520
  v_pk_fma_f32 v[68:69], v[66:67], v[24:25], v[68:69] op_sel:[1,1,0] op_sel_hi:[0,1,1] neg_lo:[0,1,0]
  v_cvt_pk_bf16_f32 v53, v50, v51
  v_pk_fma_f32 v[58:59], v[56:57], v[20:21], v[58:59] op_sel:[1,1,0] op_sel_hi:[0,1,1] neg_lo:[0,1,0]
  v_pk_mul_f32 v[42:43], v[40:41], v[30:31] op_sel:[0,0] op_sel_hi:[1,0]
  ds_write_addtid_b32 v53 offset:9792
  v_cvt_pk_bf16_f32 v61, v58, -v59
  v_pk_fma_f32 v[42:43], v[40:41], v[30:31], v[42:43] op_sel:[1,1,0] op_sel_hi:[0,1,1] neg_lo:[0,1,0]
  v_cvt_pk_bf16_f32 v77, v68, -v69
  v_pk_mul_f32 v[48:49], v[50:51], v[30:31] op_sel:[0,0] op_sel_hi:[1,0]
  ds_write_addtid_b32 v61 offset:1088
  v_cvt_pk_bf16_f32 v45, v42, v43
  ds_write_addtid_b32 v77 offset:3264
  v_pk_fma_f32 v[48:49], v[50:51], v[30:31], v[48:49] op_sel:[1,1,0] op_sel_hi:[0,1,1] neg_lo:[0,1,0]
  v_pk_mul_f32 v[56:57], v[58:59], v[20:21] op_sel:[0,0] op_sel_hi:[1,0]
  ds_write_addtid_b32 v45 offset:10064
  v_cvt_pk_bf16_f32 v52, v48, v49
  v_pk_mul_f32 v[70:71], v[68:69], v[24:25] op_sel:[0,0] op_sel_hi:[1,0]
  v_pk_fma_f32 v[56:57], v[58:59], v[20:21], v[56:57] op_sel:[1,1,0] op_sel_hi:[0,1,1] neg_lo:[0,1,0]
  v_pk_mul_f32 v[40:41], v[42:43], v[30:31] op_sel:[0,0] op_sel_hi:[1,0]
  ds_write_addtid_b32 v52 offset:10336
  v_pk_fma_f32 v[70:71], v[68:69], v[24:25], v[70:71] op_sel:[1,1,0] op_sel_hi:[0,1,1] neg_lo:[0,1,0]
  v_pk_fma_f32 v[40:41], v[42:43], v[30:31], v[40:41] op_sel:[1,1,0] op_sel_hi:[0,1,1] neg_lo:[0,1,0]
  v_cvt_pk_bf16_f32 v60, v56, -v57
  v_pk_mul_f32 v[50:51], v[48:49], v[30:31] op_sel:[0,0] op_sel_hi:[1,0]
  v_cvt_pk_bf16_f32 v76, v70, -v71
  v_cvt_pk_bf16_f32 v44, v40, v41
  ds_write_addtid_b32 v60 offset:1360
  v_pk_fma_f32 v[50:51], v[48:49], v[30:31], v[50:51] op_sel:[1,1,0] op_sel_hi:[0,1,1] neg_lo:[0,1,0]
  ds_write_addtid_b32 v76 offset:3536
  ds_write_addtid_b32 v44 offset:10608
  v_cvt_pk_bf16_f32 v53, v50, v51
  v_pk_mul_f32 v[58:59], v[56:57], v[20:21] op_sel:[0,0] op_sel_hi:[1,0]
  v_pk_mul_f32 v[72:73], v[70:71], v[24:25] op_sel:[0,0] op_sel_hi:[1,0]
  v_pk_mul_f32 v[42:43], v[40:41], v[30:31] op_sel:[0,0] op_sel_hi:[1,0]
  ds_write_addtid_b32 v53 offset:10880
  v_pk_fma_f32 v[58:59], v[56:57], v[20:21], v[58:59] op_sel:[1,1,0] op_sel_hi:[0,1,1] neg_lo:[0,1,0]
  v_pk_fma_f32 v[42:43], v[40:41], v[30:31], v[42:43] op_sel:[1,1,0] op_sel_hi:[0,1,1] neg_lo:[0,1,0]
  v_pk_fma_f32 v[72:73], v[70:71], v[24:25], v[72:73] op_sel:[1,1,0] op_sel_hi:[0,1,1] neg_lo:[0,1,0]
  v_pk_mul_f32 v[48:49], v[50:51], v[30:31] op_sel:[0,0] op_sel_hi:[1,0]
  v_cvt_pk_bf16_f32 v61, v58, -v59
  v_cvt_pk_bf16_f32 v45, v42, v43
  v_pk_fma_f32 v[48:49], v[50:51], v[30:31], v[48:49] op_sel:[1,1,0] op_sel_hi:[0,1,1] neg_lo:[0,1,0]
  v_cvt_pk_bf16_f32 v77, v72, -v73
  ds_write_addtid_b32 v61 offset:1632
  ds_write_addtid_b32 v45 offset:11152
  v_cvt_pk_bf16_f32 v52, v48, v49
  ds_write_addtid_b32 v77 offset:3808
  v_pk_mul_f32 v[56:57], v[58:59], v[20:21] op_sel:[0,0] op_sel_hi:[1,0]
  v_pk_mul_f32 v[40:41], v[42:43], v[30:31] op_sel:[0,0] op_sel_hi:[1,0]
  ds_write_addtid_b32 v52 offset:11424
  v_pk_mul_f32 v[74:75], v[72:73], v[24:25] op_sel:[0,0] op_sel_hi:[1,0]
  v_pk_fma_f32 v[40:41], v[42:43], v[30:31], v[40:41] op_sel:[1,1,0] op_sel_hi:[0,1,1] neg_lo:[0,1,0]
  v_pk_mul_f32 v[50:51], v[48:49], v[30:31] op_sel:[0,0] op_sel_hi:[1,0]
  v_pk_fma_f32 v[56:57], v[58:59], v[20:21], v[56:57] op_sel:[1,1,0] op_sel_hi:[0,1,1] neg_lo:[0,1,0]
  v_pk_fma_f32 v[74:75], v[72:73], v[24:25], v[74:75] op_sel:[1,1,0] op_sel_hi:[0,1,1] neg_lo:[0,1,0]
  v_cvt_pk_bf16_f32 v44, v40, v41
  v_pk_fma_f32 v[50:51], v[48:49], v[30:31], v[50:51] op_sel:[1,1,0] op_sel_hi:[0,1,1] neg_lo:[0,1,0]
  v_cvt_pk_bf16_f32 v60, v56, -v57
  v_cvt_pk_bf16_f32 v76, v74, -v75
  ds_write_addtid_b32 v44 offset:11696
  v_cvt_pk_bf16_f32 v53, v50, v51
  ds_write_addtid_b32 v60 offset:1904
  ds_write_addtid_b32 v76 offset:4080
  v_pk_mul_f32 v[42:43], v[40:41], v[30:31] op_sel:[0,0] op_sel_hi:[1,0]
  ds_write_addtid_b32 v53 offset:11968
  v_pk_mul_f32 v[78:79], v[62:63], v[26:27] op_sel:[0,0] op_sel_hi:[1,0]
  v_pk_mul_f32 v[48:49], v[50:51], v[30:31] op_sel:[0,0] op_sel_hi:[1,0]
  v_pk_fma_f32 v[78:79], v[62:63], v[26:27], v[78:79] op_sel:[1,1,0] op_sel_hi:[0,1,1] neg_lo:[0,1,0]
  v_pk_fma_f32 v[42:43], v[40:41], v[30:31], v[42:43] op_sel:[1,1,0] op_sel_hi:[0,1,1] neg_lo:[0,1,0]
  v_cvt_pk_bf16_f32 v82, v78, -v79
  v_cvt_pk_bf16_f32 v45, v42, v43
  v_pk_fma_f32 v[48:49], v[50:51], v[30:31], v[48:49] op_sel:[1,1,0] op_sel_hi:[0,1,1] neg_lo:[0,1,0]
  ds_write_addtid_b32 v82 offset:2448
  v_pk_mul_f32 v[80:81], v[78:79], v[26:27] op_sel:[0,0] op_sel_hi:[1,0]
  ds_write_addtid_b32 v45 offset:12240
  v_cvt_pk_bf16_f32 v52, v48, v49
  v_pk_fma_f32 v[80:81], v[78:79], v[26:27], v[80:81] op_sel:[1,1,0] op_sel_hi:[0,1,1] neg_lo:[0,1,0]
  ds_write_addtid_b32 v52 offset:12512
  v_cvt_pk_bf16_f32 v83, v80, -v81
  v_pk_mul_f32 v[40:41], v[42:43], v[30:31] op_sel:[0,0] op_sel_hi:[1,0]
  ds_write_addtid_b32 v83 offset:2720
  v_pk_mul_f32 v[50:51], v[48:49], v[30:31] op_sel:[0,0] op_sel_hi:[1,0]
  v_pk_mul_f32 v[78:79], v[80:81], v[26:27] op_sel:[0,0] op_sel_hi:[1,0]
  v_pk_fma_f32 v[40:41], v[42:43], v[30:31], v[40:41] op_sel:[1,1,0] op_sel_hi:[0,1,1] neg_lo:[0,1,0]
  v_pk_fma_f32 v[78:79], v[80:81], v[26:27], v[78:79] op_sel:[1,1,0] op_sel_hi:[0,1,1] neg_lo:[0,1,0]
  v_cvt_pk_bf16_f32 v44, v40, v41
  v_pk_fma_f32 v[50:51], v[48:49], v[30:31], v[50:51] op_sel:[1,1,0] op_sel_hi:[0,1,1] neg_lo:[0,1,0]
  v_cvt_pk_bf16_f32 v82, v78, -v79
  ds_write_addtid_b32 v82 offset:2992
  ds_write_addtid_b32 v44 offset:12784
  v_cvt_pk_bf16_f32 v53, v50, v51
  v_pk_mul_f32 v[80:81], v[78:79], v[26:27] op_sel:[0,0] op_sel_hi:[1,0]
  ds_write_addtid_b32 v53 offset:13056
  v_pk_fma_f32 v[80:81], v[78:79], v[26:27], v[80:81] op_sel:[1,1,0] op_sel_hi:[0,1,1] neg_lo:[0,1,0]
  v_pk_mul_f32 v[42:43], v[40:41], v[30:31] op_sel:[0,0] op_sel_hi:[1,0]
  v_cvt_pk_bf16_f32 v83, v80, -v81
  v_pk_mul_f32 v[48:49], v[50:51], v[30:31] op_sel:[0,0] op_sel_hi:[1,0]
  ds_write_addtid_b32 v83 offset:4352
  v_pk_fma_f32 v[42:43], v[40:41], v[30:31], v[42:43] op_sel:[1,1,0] op_sel_hi:[0,1,1] neg_lo:[0,1,0]
  v_pk_mul_f32 v[78:79], v[64:65], v[28:29] op_sel:[0,0] op_sel_hi:[1,0]
  v_cvt_pk_bf16_f32 v45, v42, v43
  v_pk_fma_f32 v[48:49], v[50:51], v[30:31], v[48:49] op_sel:[1,1,0] op_sel_hi:[0,1,1] neg_lo:[0,1,0]
  v_pk_fma_f32 v[78:79], v[64:65], v[28:29], v[78:79] op_sel:[1,1,0] op_sel_hi:[0,1,1] neg_lo:[0,1,0]
  v_cvt_pk_bf16_f32 v52, v48, v49
  v_cvt_pk_bf16_f32 v82, v78, -v79
  ds_write_addtid_b32 v45 offset:13328
  ds_write_addtid_b32 v82 offset:4896
  ds_write_addtid_b32 v52 offset:13600
  v_pk_mul_f32 v[80:81], v[78:79], v[28:29] op_sel:[0,0] op_sel_hi:[1,0]
  v_pk_mul_f32 v[40:41], v[42:43], v[30:31] op_sel:[0,0] op_sel_hi:[1,0]
  v_pk_fma_f32 v[80:81], v[78:79], v[28:29], v[80:81] op_sel:[1,1,0] op_sel_hi:[0,1,1] neg_lo:[0,1,0]
  v_pk_mul_f32 v[50:51], v[48:49], v[30:31] op_sel:[0,0] op_sel_hi:[1,0]
  v_cvt_pk_bf16_f32 v83, v80, -v81
  v_pk_fma_f32 v[40:41], v[42:43], v[30:31], v[40:41] op_sel:[1,1,0] op_sel_hi:[0,1,1] neg_lo:[0,1,0]
  ds_write_addtid_b32 v83 offset:5168
  v_pk_fma_f32 v[50:51], v[48:49], v[30:31], v[50:51] op_sel:[1,1,0] op_sel_hi:[0,1,1] neg_lo:[0,1,0]
  v_pk_mul_f32 v[78:79], v[66:67], v[28:29] op_sel:[0,0] op_sel_hi:[1,0]
  v_cvt_pk_bf16_f32 v44, v40, v41
  v_cvt_pk_bf16_f32 v53, v50, v51
  v_pk_fma_f32 v[78:79], v[66:67], v[28:29], v[78:79] op_sel:[1,1,0] op_sel_hi:[0,1,1] neg_lo:[0,1,0]
  ds_write_addtid_b32 v44 offset:13872
  v_cvt_pk_bf16_f32 v82, v78, -v79
  ds_write_addtid_b32 v53 offset:14144
  ds_write_addtid_b32 v82 offset:6800
  v_pk_mul_f32 v[42:43], v[40:41], v[30:31] op_sel:[0,0] op_sel_hi:[1,0]
  v_pk_mul_f32 v[80:81], v[78:79], v[28:29] op_sel:[0,0] op_sel_hi:[1,0]
  v_pk_mul_f32 v[48:49], v[50:51], v[30:31] op_sel:[0,0] op_sel_hi:[1,0]
  v_pk_fma_f32 v[80:81], v[78:79], v[28:29], v[80:81] op_sel:[1,1,0] op_sel_hi:[0,1,1] neg_lo:[0,1,0]
  v_pk_fma_f32 v[42:43], v[40:41], v[30:31], v[42:43] op_sel:[1,1,0] op_sel_hi:[0,1,1] neg_lo:[0,1,0]
  v_pk_fma_f32 v[48:49], v[50:51], v[30:31], v[48:49] op_sel:[1,1,0] op_sel_hi:[0,1,1] neg_lo:[0,1,0]
  v_cvt_pk_bf16_f32 v83, v80, -v81
  ds_write_addtid_b32 v83 offset:7072
  v_cvt_pk_bf16_f32 v45, v42, v43
  v_cvt_pk_bf16_f32 v52, v48, v49
  v_pk_mul_f32 v[84:85], v[68:69], v[22:23] op_sel:[0,0] op_sel_hi:[1,0]
  ds_write_addtid_b32 v45 offset:14416
  v_pk_fma_f32 v[84:85], v[68:69], v[22:23], v[84:85] op_sel:[1,1,0] op_sel_hi:[0,1,1] neg_lo:[0,1,0]
  ds_write_addtid_b32 v52 offset:14688
  v_cvt_pk_bf16_f32 v88, v84, -v85
  v_pk_mul_f32 v[40:41], v[42:43], v[30:31] op_sel:[0,0] op_sel_hi:[1,0]
  ds_write_addtid_b32 v88 offset:5440
  v_pk_mul_f32 v[50:51], v[48:49], v[30:31] op_sel:[0,0] op_sel_hi:[1,0]
  v_pk_mul_f32 v[86:87], v[70:71], v[22:23] op_sel:[0,0] op_sel_hi:[1,0]
  v_pk_fma_f32 v[40:41], v[42:43], v[30:31], v[40:41] op_sel:[1,1,0] op_sel_hi:[0,1,1] neg_lo:[0,1,0]
  v_pk_fma_f32 v[50:51], v[48:49], v[30:31], v[50:51] op_sel:[1,1,0] op_sel_hi:[0,1,1] neg_lo:[0,1,0]
  v_pk_fma_f32 v[86:87], v[70:71], v[22:23], v[86:87] op_sel:[1,1,0] op_sel_hi:[0,1,1] neg_lo:[0,1,0]
  v_cvt_pk_bf16_f32 v89, v86, -v87
  v_cvt_pk_bf16_f32 v44, v40, v41
  v_cvt_pk_bf16_f32 v53, v50, v51
  ds_write_addtid_b32 v89 offset:5712
  ds_write_addtid_b32 v44 offset:14960
  v_pk_mul_f32 v[84:85], v[72:73], v[22:23] op_sel:[0,0] op_sel_hi:[1,0]
  ds_write_addtid_b32 v53 offset:15232
  v_pk_fma_f32 v[84:85], v[72:73], v[22:23], v[84:85] op_sel:[1,1,0] op_sel_hi:[0,1,1] neg_lo:[0,1,0]
  v_pk_mul_f32 v[42:43], v[40:41], v[30:31] op_sel:[0,0] op_sel_hi:[1,0]
  v_pk_mul_f32 v[48:49], v[50:51], v[30:31] op_sel:[0,0] op_sel_hi:[1,0]
  v_cvt_pk_bf16_f32 v88, v84, -v85
  ds_write_addtid_b32 v88 offset:5984
  v_pk_fma_f32 v[42:43], v[40:41], v[30:31], v[42:43] op_sel:[1,1,0] op_sel_hi:[0,1,1] neg_lo:[0,1,0]
  v_pk_fma_f32 v[48:49], v[50:51], v[30:31], v[48:49] op_sel:[1,1,0] op_sel_hi:[0,1,1] neg_lo:[0,1,0]
  v_pk_mul_f32 v[86:87], v[74:75], v[22:23] op_sel:[0,0] op_sel_hi:[1,0]
  v_pk_fma_f32 v[86:87], v[74:75], v[22:23], v[86:87] op_sel:[1,1,0] op_sel_hi:[0,1,1] neg_lo:[0,1,0]
  v_cvt_pk_bf16_f32 v45, v42, v43
  v_cvt_pk_bf16_f32 v52, v48, v49
  v_cvt_pk_bf16_f32 v89, v86, -v87
  ds_write_addtid_b32 v45 offset:15504
  ds_write_addtid_b32 v52 offset:15776
  ds_write_addtid_b32 v89 offset:6256
  s_cmp_eq_u32 s35, 0
  s_cbranch_scc1 nb_17
  s_barrier
nb_17:
  s_waitcnt lgkmcnt(0)
  ds_read_b128 v[112:115], v11 offset:0
  ds_read_b128 v[116:119], v10 offset:7344
  ds_read_b128 v[120:123], v11 offset:32
  ds_read_b128 v[124:127], v10 offset:7376
  ds_read_b128 v[128:131], v11 offset:64
  ds_read_b128 v[132:135], v10 offset:7408
  ds_read_b128 v[136:139], v11 offset:96
  ds_read_b128 v[140:143], v10 offset:7440
  ds_read_b128 v[144:147], v11 offset:128
  ds_read_b128 v[148:151], v10 offset:7472
  ds_read_b128 v[152:155], v11 offset:160
  ds_read_b128 v[156:159], v10 offset:7504
  ds_read_b128 v[160:163], v11 offset:192
  ds_read_b128 v[164:167], v10 offset:7536
  ds_read_b128 v[168:171], v11 offset:224
  ds_read_b128 v[172:175], v10 offset:7568
  s_waitcnt lgkmcnt(14)
  v_mfma_f32_32x32x16_bf16 v[96:111], v[112:115], v[116:119], v[96:111]
  s_waitcnt lgkmcnt(12)
  v_mfma_f32_32x32x16_bf16 v[96:111], v[120:123], v[124:127], v[96:111]
  s_waitcnt lgkmcnt(10)
  v_mfma_f32_32x32x16_bf16 v[96:111], v[128:131], v[132:135], v[96:111]
  s_waitcnt lgkmcnt(8)
  v_mfma_f32_32x32x16_bf16 v[96:111], v[136:139], v[140:143], v[96:111]
  s_cmp_eq_u32 s35, 0
  s_cbranch_scc1 nb_18
  s_barrier
nb_18:
  s_waitcnt lgkmcnt(6)
  v_mfma_f32_32x32x16_bf16 v[96:111], v[144:147], v[148:151], v[96:111]
  s_waitcnt lgkmcnt(4)
  v_mfma_f32_32x32x16_bf16 v[96:111], v[152:155], v[156:159], v[96:111]
  s_waitcnt lgkmcnt(2)
  v_mfma_f32_32x32x16_bf16 v[96:111], v[160:163], v[164:167], v[96:111]
  s_waitcnt lgkmcnt(0)
  v_mfma_f32_32x32x16_bf16 v[96:111], v[168:171], v[172:175], v[96:111]
  s_cmp_lg_u32 s35, 0
  s_cbranch_scc1 gw_21
  s_cmp_eq_u32 s30, 0
  s_mov_b32 s30, 0
  s_cbranch_scc0 kg_16
  s_nop 7
  s_branch exp_20
gw_21:
  s_barrier
  s_cmp_eq_u32 s31, 0
  s_cbranch_scc1 red_19
  s_nop 7
  ds_write_addtid_b32 v96 offset:12032
  ds_write_addtid_b32 v97 offset:12288
  ds_write_addtid_b32 v98 offset:12544
  ds_write_addtid_b32 v99 offset:12800
  ds_write_addtid_b32 v100 offset:13056
  ds_write_addtid_b32 v101 offset:13312
  ds_write_addtid_b32 v102 offset:13568
  ds_write_addtid_b32 v103 offset:13824
  ds_write_addtid_b32 v104 offset:14080
  ds_write_addtid_b32 v105 offset:14336
  ds_write_addtid_b32 v106 offset:14592
  ds_write_addtid_b32 v107 offset:14848
  ds_write_addtid_b32 v108 offset:15104
  ds_write_addtid_b32 v109 offset:15360
  ds_write_addtid_b32 v110 offset:15616
  s_barrier
  s_waitcnt lgkmcnt(0)
  s_barrier
  s_branch part_5
red_19:
  s_add_u32 m0, s25, 16048
  s_barrier
  s_barrier
  ds_read_addtid_b32 v112 offset:12032
  ds_read_addtid_b32 v113 offset:12288
  ds_read_addtid_b32 v114 offset:12544
  ds_read_addtid_b32 v115 offset:12800
  ds_read_addtid_b32 v116 offset:13056
  ds_read_addtid_b32 v117 offset:13312
  ds_read_addtid_b32 v118 offset:13568
  ds_read_addtid_b32 v119 offset:13824
  ds_read_addtid_b32 v120 offset:14080
  ds_read_addtid_b32 v121 offset:14336
  ds_read_addtid_b32 v122 offset:14592
  ds_read_addtid_b32 v123 offset:14848
  ds_read_addtid_b32 v124 offset:15104
  ds_read_addtid_b32 v125 offset:15360
  ds_read_addtid_b32 v126 offset:15616
  s_barrier
  s_waitcnt lgkmcnt(0)
  v_add_f32 v96, v96, v112
  v_add_f32 v97, v97, v113
  v_add_f32 v98, v98, v114
  v_add_f32 v99, v99, v115
  v_add_f32 v100, v100, v116
  v_add_f32 v101, v101, v117
  v_add_f32 v102, v102, v118
  v_add_f32 v103, v103, v119
  v_add_f32 v104, v104, v120
  v_add_f32 v105, v105, v121
  v_add_f32 v106, v106, v122
  v_add_f32 v107, v107, v123
  v_add_f32 v108, v108, v124
  v_add_f32 v109, v109, v125
  v_add_f32 v110, v110, v126
  s_barrier
  s_barrier
  s_barrier
  s_barrier
exp_20:
  s_mul_i32 s21, s20, 4224
  s_add_u32 s21, s21, 14680064
  v_xor_b32 v1, 31, v0
  v_and_b32 v1, 31, v1
  v_lshlrev_b32 v1, 4, v1
  v_lshlrev_b32 v2, 3, v12
  v_add_u32 v2, v2, v1
  v_sub_u32 v2, 4088, v2
  v_sub_u32 v1, 2032, v1
  v_and_b32 v3, 1, v0
  v_cmp_eq_u32 vcc, 0, v3
  v_mov_b32 v4, 0
  v_lshlrev_b32 v3, 1, v0
  v_cvt_pk_bf16_f32 v20, v99, v98
  v_cvt_pk_bf16_f32 v21, v97, v96
  s_add_u32 s22, s21, 4096
  buffer_store_short v4, v3, s[12:15], s22 offen
  buffer_store_dwordx2 v[20:21], v2, s[12:15], s21 offen
  s_mov_b64 exec, 0xffffffff
  v_cvt_pk_bf16_f32 v24, v104, v103
  v_cvt_pk_bf16_f32 v25, v102, v102
  v_cvt_pk_bf16_f32 v26, v102, v101
  v_cvt_pk_bf16_f32 v27, v100, v100
  v_cvt_pk_bf16_f32 v28, v107, v107
  v_cvt_pk_bf16_f32 v29, v106, v106
  v_cvt_pk_bf16_f32 v30, v106, v105
  v_cvt_pk_bf16_f32 v31, v105, v105
  v_cvt_pk_bf16_f32 v32, v110, v110
  v_cvt_pk_bf16_f32 v33, v109, v109
  v_cvt_pk_bf16_f32 v34, v109, v108
  v_cvt_pk_bf16_f32 v35, v108, v108
  buffer_store_dwordx4 v[24:27], v1, s[12:15], s21 offen offset:1536 sc1
  buffer_store_dwordx4 v[28:31], v1, s[12:15], s21 offen offset:1024 sc1
  buffer_store_dwordx4 v[32:35], v1, s[12:15], s21 offen offset:512 sc1
  s_mov_b32 exec_lo, 0
  s_mov_b32 exec_hi, -1
  v_subrev_u32 v1, 1536, v1
  v_cndmask_b32 v37, v100, v104, vcc
  v_cvt_pk_bf16_f32 v36, v104, v104
  v_cvt_pk_bf16_f32 v37, v104, v37
  v_cvt_pk_bf16_f32 v38, v100, v100
  v_mov_b32 v39, v38
  buffer_store_dwordx4 v[36:39], v1, s[12:15], s21 offen offset:1536 sc1
  v_cndmask_b32 v41, v101, v105, vcc
  v_cvt_pk_bf16_f32 v40, v105, v105
  v_cvt_pk_bf16_f32 v41, v105, v41
  v_cvt_pk_bf16_f32 v42, v101, v101
  v_mov_b32 v43, v42
  buffer_store_dwordx4 v[40:43], v1, s[12:15], s21 offen offset:1024 sc1
  v_cndmask_b32 v45, v102, v106, vcc
  v_cvt_pk_bf16_f32 v44, v106, v106
  v_cvt_pk_bf16_f32 v45, v106, v45
  v_cvt_pk_bf16_f32 v46, v102, v102
  v_mov_b32 v47, v46
  buffer_store_dwordx4 v[44:47], v1, s[12:15], s21 offen offset:512 sc1
  v_cndmask_b32 v49, v103, v107, vcc
  v_cvt_pk_bf16_f32 v48, v107, v107
  v_cvt_pk_bf16_f32 v49, v107, v49
  v_cvt_pk_bf16_f32 v50, v103, v103
  v_mov_b32 v51, v50
  buffer_store_dwordx4 v[48:51], v1, s[12:15], s21 offen offset:0 sc1
  s_cmp_lg_u32 s35, 0
  s_cbranch_scc1 end_1
  s_cmp_ge_u32 s3, 5
  s_cbranch_scc1 end_1
  s_mov_b64 exec, -1
  s_sub_u32 s21, s18, 224
  s_mul_i32 s21, s21, 5
  s_add_u32 s21, s21, s3
  s_lshl_b32 s21, s21, 14
  s_add_u32 s21, s21, 0x1200000
  v_lshlrev_b32 v1, 4, v0
  v_mov_b32 v52, -1
  v_mov_b32 v53, -1
  v_mov_b32 v54, -1
  v_mov_b32 v55, -1
  buffer_store_dwordx4 v[52:55], v1, s[12:15], s21 offen offset:0 sc1
  buffer_store_dwordx4 v[52:55], v1, s[12:15], s21 offen offset:1024 sc1
  buffer_store_dwordx4 v[52:55], v1, s[12:15], s21 offen offset:2048 sc1
  buffer_store_dwordx4 v[52:55], v1, s[12:15], s21 offen offset:3072 sc1
  s_add_u32 s21, s21, 4096
  buffer_store_dwordx4 v[52:55], v1, s[12:15], s21 offen offset:0 sc1
  buffer_store_dwordx4 v[52:55], v1, s[12:15], s21 offen offset:1024 sc1
  buffer_store_dwordx4 v[52:55], v1, s[12:15], s21 offen offset:2048 sc1
  buffer_store_dwordx4 v[52:55], v1, s[12:15], s21 offen offset:3072 sc1
  s_add_u32 s21, s21, 4096
  buffer_store_dwordx4 v[52:55], v1, s[12:15], s21 offen offset:0 sc1
  buffer_store_dwordx4 v[52:55], v1, s[12:15], s21 offen offset:1024 sc1
  buffer_store_dwordx4 v[52:55], v1, s[12:15], s21 offen offset:2048 sc1
  buffer_store_dwordx4 v[52:55], v1, s[12:15], s21 offen offset:3072 sc1
  s_add_u32 s21, s21, 4096
  buffer_store_dwordx4 v[52:55], v1, s[12:15], s21 offen offset:0 sc1
  buffer_store_dwordx4 v[52:55], v1, s[12:15], s21 offen offset:1024 sc1
  buffer_store_dwordx4 v[52:55], v1, s[12:15], s21 offen offset:2048 sc1
  buffer_store_dwordx4 v[52:55], v1, s[12:15], s21 offen offset:3072 sc1
  s_add_u32 s21, s21, 4096
  s_endpgm
part_5:
  s_barrier
  s_barrier
  s_barrier
  s_barrier
misc_10:
  s_cmp_eq_u32 s3, 7
  s_cbranch_scc1 ut_11
  s_mov_b32 s4, s60
  s_mov_b32 s5, s61
  s_mov_b32 s6, 0x21c000
  s_mov_b32 s7, 0x00020000
  v_lshrrev_b32 v9, 5, v0
  v_mul_u32_u24 v8, 20480, v9
  v_bfe_u32 v9, v0, 4, 1
  v_mul_u32_u24 v9, 5120, v9
  v_add_u32 v8, v8, v9
  v_and_b32 v9, 15, v0
  v_lshl_add_u32 v8, v9, 3, v8
  v_lshlrev_b32 v9, 4, v0
  s_mul_i32 s21, s72, 6554
  s_lshr_b32 s21, s21, 16
  s_mul_i32 s22, s21, 10
  s_sub_u32 s22, s72, s22
  s_mul_i32 s23, s21, 40960
  s_lshl_b32 s24, s22, 7
  s_add_u32 s23, s23, s24
  s_add_u32 s24, s23, 10240
  buffer_load_dwordx2 v[176:177], v8, s[4:7], s23 offen offset:0
  buffer_load_dwordx2 v[178:179], v8, s[4:7], s23 offen offset:1280
  buffer_load_dwordx2 v[180:181], v8, s[4:7], s23 offen offset:2560
  buffer_load_dwordx2 v[182:183], v8, s[4:7], s23 offen offset:3840
  buffer_load_dwordx2 v[184:185], v8, s[4:7], s24 offen offset:0
  buffer_load_dwordx2 v[186:187], v8, s[4:7], s24 offen offset:1280
  buffer_load_dwordx2 v[188:189], v8, s[4:7], s24 offen offset:2560
  buffer_load_dwordx2 v[190:191], v8, s[4:7], s24 offen offset:3840
  s_mul_i32 s23, s22, 54
  s_add_u32 s23, s23, s21
  s_mul_i32 s23, s23, 5120
  s_sub_u32 s24, s22, 8
  s_mul_i32 s24, s24, 1105920
  s_mul_i32 s21, s21, 5120
  s_add_u32 s24, s24, s21
  s_add_u32 s24, s24, 4096
  s_movk_i32 s21, 1024
  s_cmp_ge_u32 s22, 8
  s_cselect_b32 s23, s24, s23
  s_cselect_b32 s74, 276480, s21
  s_add_u32 s23, s23, 8388608
  s_cmp_ge_u32 s72, 540
  s_cselect_b32 s73, 268435456, s23
  s_mul_i32 s21, s75, 6554
  s_lshr_b32 s21, s21, 16
  s_mul_i32 s22, s21, 10
  s_sub_u32 s22, s75, s22
  s_mul_i32 s23, s21, 40960
  s_lshl_b32 s24, s22, 7
  s_add_u32 s23, s23, s24
  s_add_u32 s24, s23, 10240
  buffer_load_dwordx2 v[192:193], v8, s[4:7], s23 offen offset:0
  buffer_load_dwordx2 v[194:195], v8, s[4:7], s23 offen offset:1280
  buffer_load_dwordx2 v[196:197], v8, s[4:7], s23 offen offset:2560
  buffer_load_dwordx2 v[198:199], v8, s[4:7], s23 offen offset:3840
  buffer_load_dwordx2 v[200:201], v8, s[4:7], s24 offen offset:0
  buffer_load_dwordx2 v[202:203], v8, s[4:7], s24 offen offset:1280
  buffer_load_dwordx2 v[204:205], v8, s[4:7], s24 offen offset:2560
  buffer_load_dwordx2 v[206:207], v8, s[4:7], s24 offen offset:3840
  s_mul_i32 s23, s22, 54
  s_add_u32 s23, s23, s21
  s_mul_i32 s23, s23, 5120
  s_sub_u32 s24, s22, 8
  s_mul_i32 s24, s24, 1105920
  s_mul_i32 s21, s21, 5120
  s_add_u32 s24, s24, s21
  s_add_u32 s24, s24, 4096
  s_movk_i32 s21, 1024
  s_cmp_ge_u32 s22, 8
  s_cselect_b32 s23, s24, s23
  s_cselect_b32 s77, 276480, s21
  s_add_u32 s23, s23, 8388608
  s_cmp_ge_u32 s75, 540
  s_cselect_b32 s76, 268435456, s23
  s_cmp_ge_u32 s78, 540
  s_cbranch_scc1 w2a_22
  s_mul_i32 s21, s78, 6554
  s_lshr_b32 s21, s21, 16
  s_mul_i32 s22, s21, 10
  s_sub_u32 s22, s78, s22
  s_mul_i32 s23, s21, 40960
  s_lshl_b32 s24, s22, 7
  s_add_u32 s23, s23, s24
  s_add_u32 s24, s23, 10240
  buffer_load_dwordx2 v[208:209], v8, s[4:7], s23 offen offset:0
  buffer_load_dwordx2 v[210:211], v8, s[4:7], s23 offen offset:1280
  buffer_load_dwordx2 v[212:213], v8, s[4:7], s23 offen offset:2560
  buffer_load_dwordx2 v[214:215], v8, s[4:7], s23 offen offset:3840
  buffer_load_dwordx2 v[216:217], v8, s[4:7], s24 offen offset:0
  buffer_load_dwordx2 v[218:219], v8, s[4:7], s24 offen offset:1280
  buffer_load_dwordx2 v[220:221], v8, s[4:7], s24 offen offset:2560
  buffer_load_dwordx2 v[222:223], v8, s[4:7], s24 offen offset:3840
  s_mul_i32 s23, s22, 54
  s_add_u32 s23, s23, s21
  s_mul_i32 s23, s23, 5120
  s_sub_u32 s24, s22, 8
  s_mul_i32 s24, s24, 1105920
  s_mul_i32 s21, s21, 5120
  s_add_u32 s24, s24, s21
  s_add_u32 s24, s24, 4096
  s_movk_i32 s21, 1024
  s_cmp_ge_u32 s22, 8
  s_cselect_b32 s23, s24, s23
  s_cselect_b32 s80, 276480, s21
  s_add_u32 s23, s23, 8388608
  s_cmp_ge_u32 s78, 540
  s_cselect_b32 s79, 268435456, s23
w2a_22:
  s_cmp_eq_u32 s35, 0
  s_cbranch_scc1 nb_24
  s_barrier
nb_24:
  s_mov_b32 s28, 0x05040100
  s_mov_b32 s29, 0x07060302
  s_waitcnt vmcnt(0)
  v_perm_b32 v64, v178, v176, s28
  v_perm_b32 v65, v182, v180, s28
  v_perm_b32 v66, v186, v184, s28
  v_perm_b32 v67, v190, v188, s28
  buffer_store_dwordx4 v[64:67], v9, s[12:15], s73 offen sc1
  s_add_u32 s73, s73, s74
  v_perm_b32 v68, v178, v176, s29
  v_perm_b32 v69, v182, v180, s29
  v_perm_b32 v70, v186, v184, s29
  v_perm_b32 v71, v190, v188, s29
  buffer_store_dwordx4 v[68:71], v9, s[12:15], s73 offen sc1
  s_add_u32 s73, s73, s74
  v_perm_b32 v72, v179, v177, s28
  v_perm_b32 v73, v183, v181, s28
  v_perm_b32 v74, v187, v185, s28
  v_perm_b32 v75, v191, v189, s28
  buffer_store_dwordx4 v[72:75], v9, s[12:15], s73 offen sc1
  s_add_u32 s73, s73, s74
  v_perm_b32 v76, v179, v177, s29
  v_perm_b32 v77, v183, v181, s29
  v_perm_b32 v78, v187, v185, s29
  v_perm_b32 v79, v191, v189, s29
  buffer_store_dwordx4 v[76:79], v9, s[12:15], s73 offen sc1
  v_perm_b32 v80, v194, v192, s28
  v_perm_b32 v81, v198, v196, s28
  v_perm_b32 v82, v202, v200, s28
  v_perm_b32 v83, v206, v204, s28
  buffer_store_dwordx4 v[80:83], v9, s[12:15], s76 offen sc1
  s_add_u32 s76, s76, s77
  v_perm_b32 v84, v194, v192, s29
  v_perm_b32 v85, v198, v196, s29
  v_perm_b32 v86, v202, v200, s29
  v_perm_b32 v87, v206, v204, s29
  buffer_store_dwordx4 v[84:87], v9, s[12:15], s76 offen sc1
  s_add_u32 s76, s76, s77
  v_perm_b32 v88, v195, v193, s28
  v_perm_b32 v89, v199, v197, s28
  v_perm_b32 v90, v203, v201, s28
  v_perm_b32 v91, v207, v205, s28
  buffer_store_dwordx4 v[88:91], v9, s[12:15], s76 offen sc1
  s_add_u32 s76, s76, s77
  v_perm_b32 v92, v195, v193, s29
  v_perm_b32 v93, v199, v197, s29
  v_perm_b32 v94, v203, v201, s29
  v_perm_b32 v95, v207, v205, s29
  buffer_store_dwordx4 v[92:95], v9, s[12:15], s76 offen sc1
  s_cmp_ge_u32 s78, 540
  s_cbranch_scc1 w2b_23
  v_perm_b32 v96, v210, v208, s28
  v_perm_b32 v97, v214, v212, s28
  v_perm_b32 v98, v218, v216, s28
  v_perm_b32 v99, v222, v220, s28
  buffer_store_dwordx4 v[96:99], v9, s[12:15], s79 offen sc1
  s_add_u32 s79, s79, s80
  v_perm_b32 v100, v210, v208, s29
  v_perm_b32 v101, v214, v212, s29
  v_perm_b32 v102, v218, v216, s29
  v_perm_b32 v103, v222, v220, s29
  buffer_store_dwordx4 v[100:103], v9, s[12:15], s79 offen sc1
  s_add_u32 s79, s79, s80
  v_perm_b32 v104, v211, v209, s28
  v_perm_b32 v105, v215, v213, s28
  v_perm_b32 v106, v219, v217, s28
  v_perm_b32 v107, v223, v221, s28
  buffer_store_dwordx4 v[104:107], v9, s[12:15], s79 offen sc1
  s_add_u32 s79, s79, s80
  v_perm_b32 v108, v211, v209, s29
  v_perm_b32 v109, v215, v213, s29
  v_perm_b32 v110, v219, v217, s29
  v_perm_b32 v111, v223, v221, s29
  buffer_store_dwordx4 v[108:111], v9, s[12:15], s79 offen sc1
w2b_23:
  s_endpgm
ut_11:
  s_mov_b32 s4, s36
  s_mov_b32 s5, s37
  s_mov_b32 s6, 0x280000
  s_mov_b32 s7, 0x00020000
  s_lshr_b32 s16, s2, 5
  s_bfe_u32 s17, s2, 0x20001
  s_lshl_b32 s17, s17, 3
  s_add_u32 s16, s16, s17
  s_bfe_u32 s17, s2, 0x20003
  s_and_b32 s23, s2, 1
  s_lshl_b32 s23, s23, 2
  s_add_u32 s17, s17, s23
  s_mul_i32 s23, s16, 81920
  s_lshl_b32 s24, s17, 7
  s_add_u32 s24, s24, s23
  s_lshl_b32 s22, s17, 5
  s_add_u32 s22, s22, s23
  s_add_u32 s22, s22, 1024
  v_lshrrev_b32 v1, 3, v0
  v_and_b32 v2, 7, v0
  v_mul_u32_u24 v3, 1280, v1
  v_lshl_add_u32 v3, v2, 4, v3
  v_lshrrev_b32 v4, 1, v0
  v_and_b32 v5, 1, v0
  v_mul_u32_u24 v6, 1280, v4
  v_lshl_add_u32 v6, v5, 4, v6
  buffer_load_dwordx4 v[176:179], v3, s[4:7], s24 offen
  s_add_u32 s24, s24, 10240
  buffer_load_dwordx4 v[180:183], v3, s[4:7], s24 offen
  s_add_u32 s24, s24, 10240
  buffer_load_dwordx4 v[184:187], v3, s[4:7], s24 offen
  s_add_u32 s24, s24, 10240
  buffer_load_dwordx4 v[188:191], v3, s[4:7], s24 offen
  s_add_u32 s24, s24, 10240
  buffer_load_dwordx4 v[192:195], v3, s[4:7], s24 offen
  s_add_u32 s24, s24, 10240
  buffer_load_dwordx4 v[196:199], v3, s[4:7], s24 offen
  s_add_u32 s24, s24, 10240
  buffer_load_dwordx4 v[200:203], v3, s[4:7], s24 offen
  s_add_u32 s24, s24, 10240
  buffer_load_dwordx4 v[204:207], v3, s[4:7], s24 offen
  s_add_u32 s24, s24, 10240
  buffer_load_dwordx4 v[208:211], v6, s[4:7], s22 offen
  s_add_u32 s22, s22, 40960
  buffer_load_dwordx4 v[212:215], v6, s[4:7], s22 offen
  s_add_u32 s22, s22, 40960
  s_cmp_eq_u32 s35, 0
  s_cbranch_scc1 nb_25
  s_barrier
nb_25:
  v_mul_u32_u24 v50, 160, v1
  v_lshl_add_u32 v50, v2, 4, v50
  v_add_u32 v50, s25, v50
  v_mul_u32_u24 v51, 160, v4
  v_lshl_add_u32 v51, v5, 4, v51
  v_add_u32 v51, s25, v51
  v_lshrrev_b32 v52, 4, v0
  v_bfe_u32 v53, v0, 2, 2
  v_lshl_add_u32 v53, v52, 3, v53
  v_mul_u32_u24 v53, 160, v53
  v_and_b32 v54, 3, v0
  v_lshl_add_u32 v53, v54, 3, v53
  v_add_u32 v53, s25, v53
  v_and_b32 v54, 15, v0
  v_mul_u32_u24 v54, 144, v54
  v_lshl_add_u32 v54, v52, 4, v54
  v_add_u32 v54, s25, v54
  v_mul_u32_u24 v55, 144, v1
  v_lshl_add_u32 v55, v2, 4, v55
  v_add_u32 v55, s25, v55
  v_lshlrev_b32 v56, 12, v1
  v_lshl_add_u32 v56, v2, 4, v56
  s_waitcnt vmcnt(0)
  ds_write_b128 v50, v[176:179] offset:0
  ds_write_b128 v50, v[180:183] offset:1280
  ds_write_b128 v50, v[184:187] offset:2560
  ds_write_b128 v50, v[188:191] offset:3840
  ds_write_b128 v50, v[192:195] offset:5120
  ds_write_b128 v50, v[196:199] offset:6400
  ds_write_b128 v50, v[200:203] offset:7680
  ds_write_b128 v50, v[204:207] offset:8960
  ds_write_b128 v51, v[208:211] offset:128
  ds_write_b128 v51, v[212:215] offset:5248
  s_waitcnt lgkmcnt(0)
  ds_read_b64_tr_b16 v[176:177], v53 offset:0
  ds_read_b64_tr_b16 v[178:179], v53 offset:640
  ds_read_b64_tr_b16 v[180:181], v53 offset:5120
  ds_read_b64_tr_b16 v[182:183], v53 offset:5760
  ds_read_b64_tr_b16 v[184:185], v53 offset:32
  ds_read_b64_tr_b16 v[186:187], v53 offset:672
  ds_read_b64_tr_b16 v[188:189], v53 offset:5152
  ds_read_b64_tr_b16 v[190:191], v53 offset:5792
  ds_read_b64_tr_b16 v[192:193], v53 offset:64
  ds_read_b64_tr_b16 v[194:195], v53 offset:704
  ds_read_b64_tr_b16 v[196:197], v53 offset:5184
  ds_read_b64_tr_b16 v[198:199], v53 offset:5824
  ds_read_b64_tr_b16 v[200:201], v53 offset:96
  ds_read_b64_tr_b16 v[202:203], v53 offset:736
  ds_read_b64_tr_b16 v[204:205], v53 offset:5216
  ds_read_b64_tr_b16 v[206:207], v53 offset:5856
  ds_read_b64_tr_b16 v[208:209], v53 offset:128
  ds_read_b64_tr_b16 v[210:211], v53 offset:768
  ds_read_b64_tr_b16 v[212:213], v53 offset:5248
  ds_read_b64_tr_b16 v[214:215], v53 offset:5888
  s_waitcnt lgkmcnt(0)
  ds_write_b128 v54, v[176:179] offset:0
  ds_write_b128 v54, v[180:183] offset:64
  ds_write_b128 v54, v[184:187] offset:2304
  ds_write_b128 v54, v[188:191] offset:2368
  ds_write_b128 v54, v[192:195] offset:4608
  ds_write_b128 v54, v[196:199] offset:4672
  ds_write_b128 v54, v[200:203] offset:6912
  ds_write_b128 v54, v[204:207] offset:6976
  ds_write_b128 v54, v[208:211] offset:9216
  ds_write_b128 v54, v[212:215] offset:9280
  s_lshl_b32 s24, s17, 18
  s_lshl_b32 s22, s16, 7
  s_add_u32 s22, s22, 11534336
  s_add_u32 s24, s24, s22
  s_lshl_b32 s26, s17, 16
  s_add_u32 s22, s22, s26
  s_add_u32 s22, s22, 2097152
  s_waitcnt lgkmcnt(0)
  ds_read_b128 v[176:179], v55 offset:0
  ds_read_b128 v[180:183], v55 offset:1152
  ds_read_b128 v[184:187], v55 offset:2304
  ds_read_b128 v[188:191], v55 offset:3456
  ds_read_b128 v[192:195], v55 offset:4608
  ds_read_b128 v[196:199], v55 offset:5760
  ds_read_b128 v[200:203], v55 offset:6912
  ds_read_b128 v[204:207], v55 offset:8064
  ds_read_b128 v[208:211], v55 offset:9216
  ds_read_b128 v[212:215], v55 offset:10368
  s_waitcnt lgkmcnt(9)
  buffer_store_dwordx4 v[176:179], v56, s[12:15], s24 offen sc1
  s_add_u32 s24, s24, 32768
  s_waitcnt lgkmcnt(8)
  buffer_store_dwordx4 v[180:183], v56, s[12:15], s24 offen sc1
  s_add_u32 s24, s24, 32768
  s_waitcnt lgkmcnt(7)
  buffer_store_dwordx4 v[184:187], v56, s[12:15], s24 offen sc1
  s_add_u32 s24, s24, 32768
  s_waitcnt lgkmcnt(6)
  buffer_store_dwordx4 v[188:191], v56, s[12:15], s24 offen sc1
  s_add_u32 s24, s24, 32768
  s_waitcnt lgkmcnt(5)
  buffer_store_dwordx4 v[192:195], v56, s[12:15], s24 offen sc1
  s_add_u32 s24, s24, 32768
  s_waitcnt lgkmcnt(4)
  buffer_store_dwordx4 v[196:199], v56, s[12:15], s24 offen sc1
  s_add_u32 s24, s24, 32768
  s_waitcnt lgkmcnt(3)
  buffer_store_dwordx4 v[200:203], v56, s[12:15], s24 offen sc1
  s_add_u32 s24, s24, 32768
  s_waitcnt lgkmcnt(2)
  buffer_store_dwordx4 v[204:207], v56, s[12:15], s24 offen sc1
  s_add_u32 s24, s24, 32768
  s_waitcnt lgkmcnt(1)
  buffer_store_dwordx4 v[208:211], v56, s[12:15], s22 offen sc1
  s_add_u32 s22, s22, 32768
  s_waitcnt lgkmcnt(0)
  buffer_store_dwordx4 v[212:215], v56, s[12:15], s22 offen sc1
  s_add_u32 s22, s22, 32768
  v_mov_b32 v62, 0
  s_lshl_b32 s24, s18, 8
  s_add_u32 s24, s24, 22085632
  v_lshlrev_b32 v61, 2, v0
  buffer_store_dword v62, v61, s[12:15], s24 offen
end_1:
  s_endpgm
.globl k2_kernel
.p2align 8
.type k2_kernel,@function
k2_kernel:
  s_cmp_ge_u32 s2, 256
  s_cbranch_scc1 end_26
  s_load_dwordx16 s[36:51], s[0:1], 0
  s_load_dwordx16 s[52:67], s[0:1], 64
  s_load_dwordx4 s[68:71], s[0:1], 128
  v_lshrrev_b32 v1, 6, v0
  v_and_b32 v0, 63, v0
  v_readfirstlane_b32 s3, v1
  s_and_b32 s22, s2, 7
  s_lshr_b32 s23, s2, 3
  s_lshr_b32 s24, s22, 1
  s_xor_b32 s24, s24, 0
  s_lshl_b32 s24, s24, 3
  s_lshr_b32 s25, s23, 2
  s_add_u32 s20, s24, s25
  s_and_b32 s22, s22, 1
  s_lshl_b32 s22, s22, 2
  s_and_b32 s23, s23, 3
  s_add_u32 s21, s22, s23
  s_xor_b32 s3, s3, 4
  s_lshl_b32 s34, s21, 6
  s_add_u32 s34, s34, s20
  s_add_u32 s35, s34, 32
  s_lshr_b32 s26, s21, 2
  s_lshl_b32 s26, s26, 6
  s_and_b32 s27, s21, 3
  s_add_u32 s26, s26, s27
  s_lshl_b32 s27, s20, 1
  s_and_b32 s27, s27, 0xfc
  s_add_u32 s76, s26, s27
  s_add_u32 s76, s76, 512
  s_and_b32 s77, s20, 1
  s_sub_u32 s77, 3, s77
  s_cmp_ge_u32 s3, 4
  s_cbranch_scc1 conv_27
  s_setprio 0
  v_lshlrev_b32 v1, 4, v0
  v_add_u32 v6, 4096, v1
  s_lshl_b32 s26, s3, 10
  v_add_u32 v251, s26, v1
  s_add_u32 s26, s3, 0
  s_and_b32 s26, s26, 3
  s_lshl_b32 s26, s26, 10
  v_add_u32 v2, s26, v1
  s_add_u32 s26, s3, 1
  s_and_b32 s26, s26, 3
  s_lshl_b32 s26, s26, 10
  v_add_u32 v3, s26, v1
  s_add_u32 s26, s3, 2
  s_and_b32 s26, s26, 3
  s_lshl_b32 s26, s26, 10
  v_add_u32 v4, s26, v1
  s_add_u32 s26, s3, 3
  s_and_b32 s26, s26, 3
  s_lshl_b32 s26, s26, 10
  v_add_u32 v5, s26, v1
  s_mul_i32 s26, s20, 221184
  s_mul_i32 s27, s21, 276480
  s_lshl_b32 s28, s3, 12
  s_mul_i32 s29, s3, 5120
  s_waitcnt lgkmcnt(0)
  s_add_u32 s4, s70, s26
  s_addc_u32 s5, s71, 0
  s_mov_b32 s6, 221184
  s_mov_b32 s7, 0x00020000
  s_add_u32 s27, s27, 0x800000
  s_add_u32 s8, s70, s27
  s_addc_u32 s9, s71, 0
  s_mov_b32 s10, 276480
  s_mov_b32 s11, 0x00020000
  s_mov_b32 s12, s70
  s_mov_b32 s13, s71
  s_mov_b32 s14, 0x10000000
  s_mov_b32 s15, 0x00020000
  s_mul_i32 s26, s35, 4224
  s_add_u32 s26, s26, 0xe00000
  s_lshl_b32 s27, s35, 12
  s_add_u32 s27, s27, 0xb00000
  buffer_load_dwordx4 v[16:19], v251, s[12:15], s26 offen
  buffer_load_dwordx2 v[20:21], v251, s[12:15], s26 offen offset:16
  buffer_load_dwordx4 v[22:25], v251, s[12:15], s27 offen
  s_mul_i32 s26, s76, 4224
  s_add_u32 s26, s26, 0xe00000
  s_lshl_b32 s27, s76, 12
  s_add_u32 s27, s27, 0xb00000
  buffer_load_dwordx4 v[26:29], v251, s[12:15], s26 offen
  buffer_load_dwordx2 v[30:31], v251, s[12:15], s26 offen offset:16
  buffer_load_dwordx4 v[32:35], v251, s[12:15], s27 offen
  buffer_load_dwordx4 v[108:111], v5, s[4:7], s28 offen
  buffer_load_dwordx4 v[112:115], v1, s[8:11], s29 offen offset:0
  buffer_load_dwordx4 v[116:119], v1, s[8:11], s29 offen offset:1024
  buffer_load_dwordx4 v[120:123], v1, s[8:11], s29 offen offset:2048
  buffer_load_dwordx4 v[124:127], v1, s[8:11], s29 offen offset:3072
  buffer_load_dwordx4 v[128:131], v6, s[8:11], s29 offen offset:0
  buffer_load_dwordx4 v[104:107], v4, s[4:7], s28 offen
  buffer_load_dwordx4 v[100:103], v3, s[4:7], s28 offen
  buffer_load_dwordx4 v[96:99], v2, s[4:7], s28 offen
  s_add_u32 s28, s28, 16384
  s_add_u32 s29, s29, 20480
  s_barrier
  buffer_load_dwordx4 v[144:147], v5, s[4:7], s28 offen
  buffer_load_dwordx4 v[148:151], v1, s[8:11], s29 offen offset:0
  buffer_load_dwordx4 v[152:155], v1, s[8:11], s29 offen offset:1024
  buffer_load_dwordx4 v[156:159], v1, s[8:11], s29 offen offset:2048
  buffer_load_dwordx4 v[160:163], v1, s[8:11], s29 offen offset:3072
  buffer_load_dwordx4 v[164:167], v6, s[8:11], s29 offen offset:0
  buffer_load_dwordx4 v[140:143], v4, s[4:7], s28 offen
  buffer_load_dwordx4 v[136:139], v3, s[4:7], s28 offen
  buffer_load_dwordx4 v[132:135], v2, s[4:7], s28 offen
  s_add_u32 s28, s28, 16384
  s_add_u32 s29, s29, 20480
  buffer_load_dwordx4 v[180:183], v5, s[4:7], s28 offen
  buffer_load_dwordx4 v[184:187], v1, s[8:11], s29 offen offset:0
  buffer_load_dwordx4 v[188:191], v1, s[8:11], s29 offen offset:1024
  buffer_load_dwordx4 v[192:195], v1, s[8:11], s29 offen offset:2048
  buffer_load_dwordx4 v[196:199], v1, s[8:11], s29 offen offset:3072
  buffer_load_dwordx4 v[200:203], v6, s[8:11], s29 offen offset:0
  buffer_load_dwordx4 v[176:179], v4, s[4:7], s28 offen
  buffer_load_dwordx4 v[172:175], v3, s[4:7], s28 offen
  buffer_load_dwordx4 v[168:171], v2, s[4:7], s28 offen
  s_add_u32 s28, s28, 16384
  s_add_u32 s29, s29, 20480
  s_mov_b32 s16, s66
  s_mov_b32 s17, s67
  s_mov_b32 s18, 0x280000
  s_mov_b32 s19, 0x00020000
  v_mov_b32 v252, 157952
  v_mov_b32 v253, 1
  s_lshl_b32 s26, s20, 2
  s_add_u32 s26, s26, s3
  s_lshl_b32 s27, s26, 6
  s_add_u32 s27, s27, 0x1500000
  v_lshrrev_b32 v7, 4, v0
  v_lshlrev_b32 v12, 4, v7
  buffer_load_dwordx4 v[8:11], v12, s[12:15], s27 offen
  s_mul_i32 s30, s26, 20480
  v_mul_u32_u24 v7, 5120, v7
  v_and_b32 v12, 15, v0
  s_lshr_b32 s26, s21, 2
  s_lshl_b32 s26, s26, 6
  s_and_b32 s27, s21, 3
  s_add_u32 s26, s26, s27
  s_add_u32 s26, s26, 512
  v_lshl_add_u32 v13, v12, 2, s26
  v_lshl_add_u32 v13, v13, 1, v7
  s_lshl_b32 s26, s21, 7
  v_lshl_add_u32 v12, v12, 3, v7
  v_add_u32 v12, s26, v12
  s_mul_i32 s26, s3, 15360
  s_add_u32 s26, s26, 96512
  v_lshl_add_u32 v14, v0, 2, s26
  s_mul_i32 s26, s3, 5120
  s_add_u32 s26, s26, 63744
  v_add_u32 v15, s26, v1
  s_add_u32 s26, s3, 1
  s_and_b32 s26, s26, 3
  s_mul_i32 s26, s26, 15360
  s_add_u32 s78, s26, 96512
  s_add_u32 s26, s3, 2
  s_and_b32 s26, s26, 3
  s_mul_i32 s26, s26, 15360
  s_add_u32 s79, s26, 101632
  s_add_u32 s26, s3, 3
  s_and_b32 s26, s26, 3
  s_mul_i32 s26, s26, 15360
  s_add_u32 s80, s26, 106752
  s_waitcnt vmcnt(31)
  ds_write_b128 v251, v[22:25] offset:38368
  v_alignbit_b32 v36, v17, v16, 16
  v_alignbit_b32 v37, v18, v17, 16
  v_alignbit_b32 v38, v19, v18, 16
  v_alignbit_b32 v39, v20, v19, 16
  ds_write_b128 v251, v[16:19] offset:21248
  v_mov_b32 v40, v17
  v_mov_b32 v41, v18
  v_mov_b32 v42, v19
  v_mov_b32 v43, v20
  ds_write_b128 v251, v[36:39] offset:25408
  v_alignbit_b32 v44, v18, v17, 16
  v_alignbit_b32 v45, v19, v18, 16
  v_alignbit_b32 v46, v20, v19, 16
  v_alignbit_b32 v47, v21, v20, 16
  ds_write_b128 v251, v[40:43] offset:29568
  ds_write_b128 v251, v[44:47] offset:33728
  s_cmp_eq_u32 s77, 2
  s_cbranch_scc1 n3_28
  s_waitcnt vmcnt(28)
  ds_write_b128 v251, v[32:35] offset:59616
  v_alignbit_b32 v48, v27, v26, 16
  v_alignbit_b32 v49, v28, v27, 16
  v_alignbit_b32 v50, v29, v28, 16
  v_alignbit_b32 v51, v30, v29, 16
  ds_write_b128 v251, v[26:29] offset:42496
  v_mov_b32 v52, v27
  v_mov_b32 v53, v28
  v_mov_b32 v54, v29
  v_mov_b32 v55, v30
  ds_write_b128 v251, v[48:51] offset:46656
  v_alignbit_b32 v56, v28, v27, 16
  v_alignbit_b32 v57, v29, v28, 16
  v_alignbit_b32 v58, v30, v29, 16
  v_alignbit_b32 v59, v31, v30, 16
  ds_write_b128 v251, v[52:55] offset:50816
  ds_write_b128 v251, v[56:59] offset:54976
n3_28:
  s_mov_b64 exec, 1
  ds_add_u32 v252, v253 offset:4
  s_mov_b64 exec, -1
  s_waitcnt vmcnt(19)
  v_mfma_f32_16x16x32_bf16 v[76:79], v[108:111], v[112:115], 0
  v_mfma_f32_16x16x32_bf16 v[80:83], v[108:111], v[116:119], 0
  buffer_load_dwordx4 v[216:219], v5, s[4:7], s28 offen
  v_mfma_f32_16x16x32_bf16 v[84:87], v[108:111], v[120:123], 0
  v_mfma_f32_16x16x32_bf16 v[88:91], v[108:111], v[124:127], 0
  buffer_load_dwordx4 v[220:223], v1, s[8:11], s29 offen offset:0
  v_mfma_f32_16x16x32_bf16 v[92:95], v[108:111], v[128:131], 0
  v_mfma_f32_16x16x32_bf16 v[56:59], v[104:107], v[112:115], 0
  buffer_load_dwordx4 v[224:227], v1, s[8:11], s29 offen offset:1024
  v_mfma_f32_16x16x32_bf16 v[60:63], v[104:107], v[116:119], 0
  v_mfma_f32_16x16x32_bf16 v[64:67], v[104:107], v[120:123], 0
  buffer_load_dwordx4 v[228:231], v1, s[8:11], s29 offen offset:2048
  v_mfma_f32_16x16x32_bf16 v[68:71], v[104:107], v[124:127], 0
  v_mfma_f32_16x16x32_bf16 v[72:75], v[104:107], v[128:131], 0
  buffer_load_dwordx4 v[232:235], v1, s[8:11], s29 offen offset:3072
  v_mfma_f32_16x16x32_bf16 v[36:39], v[100:103], v[112:115], 0
  v_mfma_f32_16x16x32_bf16 v[40:43], v[100:103], v[116:119], 0
  buffer_load_dwordx4 v[236:239], v6, s[8:11], s29 offen offset:0
  v_mfma_f32_16x16x32_bf16 v[44:47], v[100:103], v[120:123], 0
  v_mfma_f32_16x16x32_bf16 v[48:51], v[100:103], v[124:127], 0
  buffer_load_dwordx4 v[212:215], v4, s[4:7], s28 offen
  v_mfma_f32_16x16x32_bf16 v[52:55], v[100:103], v[128:131], 0
  v_mfma_f32_16x16x32_bf16 v[16:19], v[96:99], v[112:115], 0
  buffer_load_dwordx4 v[208:211], v3, s[4:7], s28 offen
  v_mfma_f32_16x16x32_bf16 v[20:23], v[96:99], v[116:119], 0
  v_mfma_f32_16x16x32_bf16 v[24:27], v[96:99], v[120:123], 0
  buffer_load_dwordx4 v[204:207], v2, s[4:7], s28 offen
  s_add_u32 s28, s28, 16384
  s_add_u32 s29, s29, 20480
  v_mfma_f32_16x16x32_bf16 v[28:31], v[96:99], v[124:127], 0
  v_mfma_f32_16x16x32_bf16 v[32:35], v[96:99], v[128:131], 0
  s_waitcnt vmcnt(19)
  v_mfma_f32_16x16x32_bf16 v[76:79], v[144:147], v[148:151], v[76:79]
  v_mfma_f32_16x16x32_bf16 v[80:83], v[144:147], v[152:155], v[80:83]
  buffer_load_dwordx4 v[108:111], v5, s[4:7], s28 offen
  v_mfma_f32_16x16x32_bf16 v[84:87], v[144:147], v[156:159], v[84:87]
  v_mfma_f32_16x16x32_bf16 v[88:91], v[144:147], v[160:163], v[88:91]
  buffer_load_dwordx4 v[112:115], v1, s[8:11], s29 offen offset:0
  v_mfma_f32_16x16x32_bf16 v[92:95], v[144:147], v[164:167], v[92:95]
  v_mfma_f32_16x16x32_bf16 v[56:59], v[140:143], v[148:151], v[56:59]
  buffer_load_dwordx4 v[116:119], v1, s[8:11], s29 offen offset:1024
  v_mfma_f32_16x16x32_bf16 v[60:63], v[140:143], v[152:155], v[60:63]
  v_mfma_f32_16x16x32_bf16 v[64:67], v[140:143], v[156:159], v[64:67]
  buffer_load_dwordx4 v[120:123], v1, s[8:11], s29 offen offset:2048
  v_mfma_f32_16x16x32_bf16 v[68:71], v[140:143], v[160:163], v[68:71]
  v_mfma_f32_16x16x32_bf16 v[72:75], v[140:143], v[164:167], v[72:75]
  buffer_load_dwordx4 v[124:127], v1, s[8:11], s29 offen offset:3072
  v_mfma_f32_16x16x32_bf16 v[36:39], v[136:139], v[148:151], v[36:39]
  v_mfma_f32_16x16x32_bf16 v[40:43], v[136:139], v[152:155], v[40:43]
  buffer_load_dwordx4 v[128:131], v6, s[8:11], s29 offen offset:0
  v_mfma_f32_16x16x32_bf16 v[44:47], v[136:139], v[156:159], v[44:47]
  v_mfma_f32_16x16x32_bf16 v[48:51], v[136:139], v[160:163], v[48:51]
  buffer_load_dwordx4 v[104:107], v4, s[4:7], s28 offen
  v_mfma_f32_16x16x32_bf16 v[52:55], v[136:139], v[164:167], v[52:55]
  v_mfma_f32_16x16x32_bf16 v[16:19], v[132:135], v[148:151], v[16:19]
  buffer_load_dwordx4 v[100:103], v3, s[4:7], s28 offen
  v_mfma_f32_16x16x32_bf16 v[20:23], v[132:135], v[152:155], v[20:23]
  v_mfma_f32_16x16x32_bf16 v[24:27], v[132:135], v[156:159], v[24:27]
  buffer_load_dwordx4 v[96:99], v2, s[4:7], s28 offen
  s_add_u32 s28, s28, 16384
  s_add_u32 s29, s29, 20480
  v_mfma_f32_16x16x32_bf16 v[28:31], v[132:135], v[160:163], v[28:31]
  v_mfma_f32_16x16x32_bf16 v[32:35], v[132:135], v[164:167], v[32:35]
  s_waitcnt vmcnt(19)
  v_mfma_f32_16x16x32_bf16 v[76:79], v[180:183], v[184:187], v[76:79]
  v_mfma_f32_16x16x32_bf16 v[80:83], v[180:183], v[188:191], v[80:83]
  buffer_load_dwordx4 v[144:147], v5, s[4:7], s28 offen
  v_mfma_f32_16x16x32_bf16 v[84:87], v[180:183], v[192:195], v[84:87]
  v_mfma_f32_16x16x32_bf16 v[88:91], v[180:183], v[196:199], v[88:91]
  buffer_load_dwordx4 v[148:151], v1, s[8:11], s29 offen offset:0
  v_mfma_f32_16x16x32_bf16 v[92:95], v[180:183], v[200:203], v[92:95]
  v_mfma_f32_16x16x32_bf16 v[56:59], v[176:179], v[184:187], v[56:59]
  buffer_load_dwordx4 v[152:155], v1, s[8:11], s29 offen offset:1024
  v_mfma_f32_16x16x32_bf16 v[60:63], v[176:179], v[188:191], v[60:63]
  v_mfma_f32_16x16x32_bf16 v[64:67], v[176:179], v[192:195], v[64:67]
  buffer_load_dwordx4 v[156:159], v1, s[8:11], s29 offen offset:2048
  v_mfma_f32_16x16x32_bf16 v[68:71], v[176:179], v[196:199], v[68:71]
  v_mfma_f32_16x16x32_bf16 v[72:75], v[176:179], v[200:203], v[72:75]
  buffer_load_dwordx4 v[160:163], v1, s[8:11], s29 offen offset:3072
  v_mfma_f32_16x16x32_bf16 v[36:39], v[172:175], v[184:187], v[36:39]
  v_mfma_f32_16x16x32_bf16 v[40:43], v[172:175], v[188:191], v[40:43]
  buffer_load_dwordx4 v[164:167], v6, s[8:11], s29 offen offset:0
  v_mfma_f32_16x16x32_bf16 v[44:47], v[172:175], v[192:195], v[44:47]
  v_mfma_f32_16x16x32_bf16 v[48:51], v[172:175], v[196:199], v[48:51]
  buffer_load_dwordx4 v[140:143], v4, s[4:7], s28 offen
  v_mfma_f32_16x16x32_bf16 v[52:55], v[172:175], v[200:203], v[52:55]
  v_mfma_f32_16x16x32_bf16 v[16:19], v[168:171], v[184:187], v[16:19]
  buffer_load_dwordx4 v[136:139], v3, s[4:7], s28 offen
  v_mfma_f32_16x16x32_bf16 v[20:23], v[168:171], v[188:191], v[20:23]
  v_mfma_f32_16x16x32_bf16 v[24:27], v[168:171], v[192:195], v[24:27]
  buffer_load_dwordx4 v[132:135], v2, s[4:7], s28 offen
  s_add_u32 s28, s28, 16384
  s_add_u32 s29, s29, 20480
  v_mfma_f32_16x16x32_bf16 v[28:31], v[168:171], v[196:199], v[28:31]
  v_mfma_f32_16x16x32_bf16 v[32:35], v[168:171], v[200:203], v[32:35]
  s_waitcnt vmcnt(18)
  v_mfma_f32_16x16x32_bf16 v[76:79], v[216:219], v[220:223], v[76:79]
  v_mfma_f32_16x16x32_bf16 v[80:83], v[216:219], v[224:227], v[80:83]
  buffer_load_dwordx4 v[180:183], v5, s[4:7], s28 offen
  v_mfma_f32_16x16x32_bf16 v[84:87], v[216:219], v[228:231], v[84:87]
  v_mfma_f32_16x16x32_bf16 v[88:91], v[216:219], v[232:235], v[88:91]
  buffer_load_dwordx4 v[184:187], v1, s[8:11], s29 offen offset:0
  v_mfma_f32_16x16x32_bf16 v[92:95], v[216:219], v[236:239], v[92:95]
  v_mfma_f32_16x16x32_bf16 v[56:59], v[212:215], v[220:223], v[56:59]
  buffer_load_dwordx4 v[188:191], v1, s[8:11], s29 offen offset:1024
  v_mfma_f32_16x16x32_bf16 v[60:63], v[212:215], v[224:227], v[60:63]
  v_mfma_f32_16x16x32_bf16 v[64:67], v[212:215], v[228:231], v[64:67]
  buffer_load_dwordx4 v[192:195], v1, s[8:11], s29 offen offset:2048
  v_mfma_f32_16x16x32_bf16 v[68:71], v[212:215], v[232:235], v[68:71]
  v_mfma_f32_16x16x32_bf16 v[72:75], v[212:215], v[236:239], v[72:75]
  buffer_load_dwordx4 v[196:199], v1, s[8:11], s29 offen offset:3072
  v_mfma_f32_16x16x32_bf16 v[36:39], v[208:211], v[220:223], v[36:39]
  v_mfma_f32_16x16x32_bf16 v[40:43], v[208:211], v[224:227], v[40:43]
  buffer_load_dwordx4 v[200:203], v6, s[8:11], s29 offen offset:0
  v_mfma_f32_16x16x32_bf16 v[44:47], v[208:211], v[228:231], v[44:47]
  v_mfma_f32_16x16x32_bf16 v[48:51], v[208:211], v[232:235], v[48:51]
  buffer_load_dwordx4 v[176:179], v4, s[4:7], s28 offen
  v_mfma_f32_16x16x32_bf16 v[52:55], v[208:211], v[236:239], v[52:55]
  v_mfma_f32_16x16x32_bf16 v[16:19], v[204:207], v[220:223], v[16:19]
  buffer_load_dwordx4 v[172:175], v3, s[4:7], s28 offen
  v_mfma_f32_16x16x32_bf16 v[20:23], v[204:207], v[224:227], v[20:23]
  v_mfma_f32_16x16x32_bf16 v[24:27], v[204:207], v[228:231], v[24:27]
  buffer_load_dwordx4 v[168:171], v2, s[4:7], s28 offen
  s_add_u32 s28, s28, 16384
  s_add_u32 s29, s29, 20480
  v_mfma_f32_16x16x32_bf16 v[28:31], v[204:207], v[232:235], v[28:31]
  v_mfma_f32_16x16x32_bf16 v[32:35], v[204:207], v[236:239], v[32:35]
  s_waitcnt vmcnt(18)
  v_mfma_f32_16x16x32_bf16 v[76:79], v[108:111], v[112:115], v[76:79]
  v_mfma_f32_16x16x32_bf16 v[80:83], v[108:111], v[116:119], v[80:83]
  buffer_load_dwordx4 v[216:219], v5, s[4:7], s28 offen
  v_mfma_f32_16x16x32_bf16 v[84:87], v[108:111], v[120:123], v[84:87]
  v_mfma_f32_16x16x32_bf16 v[88:91], v[108:111], v[124:127], v[88:91]
  buffer_load_dwordx4 v[220:223], v1, s[8:11], s29 offen offset:0
  v_mfma_f32_16x16x32_bf16 v[92:95], v[108:111], v[128:131], v[92:95]
  v_mfma_f32_16x16x32_bf16 v[56:59], v[104:107], v[112:115], v[56:59]
  buffer_load_dwordx4 v[224:227], v1, s[8:11], s29 offen offset:1024
  v_mfma_f32_16x16x32_bf16 v[60:63], v[104:107], v[116:119], v[60:63]
  v_mfma_f32_16x16x32_bf16 v[64:67], v[104:107], v[120:123], v[64:67]
  buffer_load_dwordx4 v[228:231], v1, s[8:11], s29 offen offset:2048
  v_mfma_f32_16x16x32_bf16 v[68:71], v[104:107], v[124:127], v[68:71]
  v_mfma_f32_16x16x32_bf16 v[72:75], v[104:107], v[128:131], v[72:75]
  buffer_load_dwordx4 v[232:235], v1, s[8:11], s29 offen offset:3072
  v_mfma_f32_16x16x32_bf16 v[36:39], v[100:103], v[112:115], v[36:39]
  v_mfma_f32_16x16x32_bf16 v[40:43], v[100:103], v[116:119], v[40:43]
  buffer_load_dwordx4 v[236:239], v6, s[8:11], s29 offen offset:0
  v_mfma_f32_16x16x32_bf16 v[44:47], v[100:103], v[120:123], v[44:47]
  v_mfma_f32_16x16x32_bf16 v[48:51], v[100:103], v[124:127], v[48:51]
  buffer_load_dwordx4 v[212:215], v4, s[4:7], s28 offen
  v_mfma_f32_16x16x32_bf16 v[52:55], v[100:103], v[128:131], v[52:55]
  v_mfma_f32_16x16x32_bf16 v[16:19], v[96:99], v[112:115], v[16:19]
  buffer_load_dwordx4 v[208:211], v3, s[4:7], s28 offen
  v_mfma_f32_16x16x32_bf16 v[20:23], v[96:99], v[116:119], v[20:23]
  v_mfma_f32_16x16x32_bf16 v[24:27], v[96:99], v[120:123], v[24:27]
  buffer_load_dwordx4 v[204:207], v2, s[4:7], s28 offen
  s_add_u32 s28, s28, 16384
  s_add_u32 s29, s29, 20480
  v_mfma_f32_16x16x32_bf16 v[28:31], v[96:99], v[124:127], v[28:31]
  v_mfma_f32_16x16x32_bf16 v[32:35], v[96:99], v[128:131], v[32:35]
  s_waitcnt vmcnt(18)
  v_mfma_f32_16x16x32_bf16 v[76:79], v[144:147], v[148:151], v[76:79]
  v_mfma_f32_16x16x32_bf16 v[80:83], v[144:147], v[152:155], v[80:83]
  buffer_load_dwordx4 v[108:111], v5, s[4:7], s28 offen
  v_mfma_f32_16x16x32_bf16 v[84:87], v[144:147], v[156:159], v[84:87]
  v_mfma_f32_16x16x32_bf16 v[88:91], v[144:147], v[160:163], v[88:91]
  buffer_load_dwordx4 v[112:115], v1, s[8:11], s29 offen offset:0
  v_mfma_f32_16x16x32_bf16 v[92:95], v[144:147], v[164:167], v[92:95]
  v_mfma_f32_16x16x32_bf16 v[56:59], v[140:143], v[148:151], v[56:59]
  buffer_load_dwordx4 v[116:119], v1, s[8:11], s29 offen offset:1024
  v_mfma_f32_16x16x32_bf16 v[60:63], v[140:143], v[152:155], v[60:63]
  v_mfma_f32_16x16x32_bf16 v[64:67], v[140:143], v[156:159], v[64:67]
  buffer_load_dwordx4 v[120:123], v1, s[8:11], s29 offen offset:2048
  v_mfma_f32_16x16x32_bf16 v[68:71], v[140:143], v[160:163], v[68:71]
  v_mfma_f32_16x16x32_bf16 v[72:75], v[140:143], v[164:167], v[72:75]
  buffer_load_dwordx4 v[124:127], v1, s[8:11], s29 offen offset:3072
  v_mfma_f32_16x16x32_bf16 v[36:39], v[136:139], v[148:151], v[36:39]
  v_mfma_f32_16x16x32_bf16 v[40:43], v[136:139], v[152:155], v[40:43]
  buffer_load_dwordx4 v[128:131], v6, s[8:11], s29 offen offset:0
  v_mfma_f32_16x16x32_bf16 v[44:47], v[136:139], v[156:159], v[44:47]
  v_mfma_f32_16x16x32_bf16 v[48:51], v[136:139], v[160:163], v[48:51]
  buffer_load_dwordx4 v[104:107], v4, s[4:7], s28 offen
  v_mfma_f32_16x16x32_bf16 v[52:55], v[136:139], v[164:167], v[52:55]
  v_mfma_f32_16x16x32_bf16 v[16:19], v[132:135], v[148:151], v[16:19]
  buffer_load_dwordx4 v[100:103], v3, s[4:7], s28 offen
  v_mfma_f32_16x16x32_bf16 v[20:23], v[132:135], v[152:155], v[20:23]
  v_mfma_f32_16x16x32_bf16 v[24:27], v[132:135], v[156:159], v[24:27]
  buffer_load_dwordx4 v[96:99], v2, s[4:7], s28 offen
  s_add_u32 s28, s28, 16384
  s_add_u32 s29, s29, 20480
  v_mfma_f32_16x16x32_bf16 v[28:31], v[132:135], v[160:163], v[28:31]
  v_mfma_f32_16x16x32_bf16 v[32:35], v[132:135], v[164:167], v[32:35]
  s_waitcnt vmcnt(18)
  v_mfma_f32_16x16x32_bf16 v[76:79], v[180:183], v[184:187], v[76:79]
  v_mfma_f32_16x16x32_bf16 v[80:83], v[180:183], v[188:191], v[80:83]
  buffer_load_dwordx4 v[144:147], v5, s[4:7], s28 offen
  v_mfma_f32_16x16x32_bf16 v[84:87], v[180:183], v[192:195], v[84:87]
  v_mfma_f32_16x16x32_bf16 v[88:91], v[180:183], v[196:199], v[88:91]
  buffer_load_dwordx4 v[148:151], v1, s[8:11], s29 offen offset:0
  v_mfma_f32_16x16x32_bf16 v[92:95], v[180:183], v[200:203], v[92:95]
  v_mfma_f32_16x16x32_bf16 v[56:59], v[176:179], v[184:187], v[56:59]
  buffer_load_dwordx4 v[152:155], v1, s[8:11], s29 offen offset:1024
  v_mfma_f32_16x16x32_bf16 v[60:63], v[176:179], v[188:191], v[60:63]
  v_mfma_f32_16x16x32_bf16 v[64:67], v[176:179], v[192:195], v[64:67]
  buffer_load_dwordx4 v[156:159], v1, s[8:11], s29 offen offset:2048
  v_mfma_f32_16x16x32_bf16 v[68:71], v[176:179], v[196:199], v[68:71]
  v_mfma_f32_16x16x32_bf16 v[72:75], v[176:179], v[200:203], v[72:75]
  buffer_load_dwordx4 v[160:163], v1, s[8:11], s29 offen offset:3072
  v_mfma_f32_16x16x32_bf16 v[36:39], v[172:175], v[184:187], v[36:39]
  v_mfma_f32_16x16x32_bf16 v[40:43], v[172:175], v[188:191], v[40:43]
  buffer_load_dwordx4 v[164:167], v6, s[8:11], s29 offen offset:0
  v_mfma_f32_16x16x32_bf16 v[44:47], v[172:175], v[192:195], v[44:47]
  v_mfma_f32_16x16x32_bf16 v[48:51], v[172:175], v[196:199], v[48:51]
  buffer_load_dwordx4 v[140:143], v4, s[4:7], s28 offen
  v_mfma_f32_16x16x32_bf16 v[52:55], v[172:175], v[200:203], v[52:55]
  v_mfma_f32_16x16x32_bf16 v[16:19], v[168:171], v[184:187], v[16:19]
  buffer_load_dwordx4 v[136:139], v3, s[4:7], s28 offen
  v_mfma_f32_16x16x32_bf16 v[20:23], v[168:171], v[188:191], v[20:23]
  v_mfma_f32_16x16x32_bf16 v[24:27], v[168:171], v[192:195], v[24:27]
  buffer_load_dwordx4 v[132:135], v2, s[4:7], s28 offen
  s_add_u32 s28, s28, 16384
  s_add_u32 s29, s29, 20480
  v_mfma_f32_16x16x32_bf16 v[28:31], v[168:171], v[196:199], v[28:31]
  v_mfma_f32_16x16x32_bf16 v[32:35], v[168:171], v[200:203], v[32:35]
  s_waitcnt vmcnt(18)
  v_mfma_f32_16x16x32_bf16 v[76:79], v[216:219], v[220:223], v[76:79]
  v_mfma_f32_16x16x32_bf16 v[80:83], v[216:219], v[224:227], v[80:83]
  buffer_load_dwordx4 v[180:183], v5, s[4:7], s28 offen
  v_mfma_f32_16x16x32_bf16 v[84:87], v[216:219], v[228:231], v[84:87]
  v_mfma_f32_16x16x32_bf16 v[88:91], v[216:219], v[232:235], v[88:91]
  buffer_load_dwordx4 v[184:187], v1, s[8:11], s29 offen offset:0
  v_mfma_f32_16x16x32_bf16 v[92:95], v[216:219], v[236:239], v[92:95]
  v_mfma_f32_16x16x32_bf16 v[56:59], v[212:215], v[220:223], v[56:59]
  buffer_load_dwordx4 v[188:191], v1, s[8:11], s29 offen offset:1024
  v_mfma_f32_16x16x32_bf16 v[60:63], v[212:215], v[224:227], v[60:63]
  v_mfma_f32_16x16x32_bf16 v[64:67], v[212:215], v[228:231], v[64:67]
  buffer_load_dwordx4 v[192:195], v1, s[8:11], s29 offen offset:2048
  v_mfma_f32_16x16x32_bf16 v[68:71], v[212:215], v[232:235], v[68:71]
  v_mfma_f32_16x16x32_bf16 v[72:75], v[212:215], v[236:239], v[72:75]
  buffer_load_dwordx4 v[196:199], v1, s[8:11], s29 offen offset:3072
  v_mfma_f32_16x16x32_bf16 v[36:39], v[208:211], v[220:223], v[36:39]
  v_mfma_f32_16x16x32_bf16 v[40:43], v[208:211], v[224:227], v[40:43]
  buffer_load_dwordx4 v[200:203], v6, s[8:11], s29 offen offset:0
  v_mfma_f32_16x16x32_bf16 v[44:47], v[208:211], v[228:231], v[44:47]
  v_mfma_f32_16x16x32_bf16 v[48:51], v[208:211], v[232:235], v[48:51]
  buffer_load_dwordx4 v[176:179], v4, s[4:7], s28 offen
  v_mfma_f32_16x16x32_bf16 v[52:55], v[208:211], v[236:239], v[52:55]
  v_mfma_f32_16x16x32_bf16 v[16:19], v[204:207], v[220:223], v[16:19]
  buffer_load_dwordx4 v[172:175], v3, s[4:7], s28 offen
  v_mfma_f32_16x16x32_bf16 v[20:23], v[204:207], v[224:227], v[20:23]
  v_mfma_f32_16x16x32_bf16 v[24:27], v[204:207], v[228:231], v[24:27]
  buffer_load_dwordx4 v[168:171], v2, s[4:7], s28 offen
  s_add_u32 s28, s28, 16384
  s_add_u32 s29, s29, 20480
  v_mfma_f32_16x16x32_bf16 v[28:31], v[204:207], v[232:235], v[28:31]
  v_mfma_f32_16x16x32_bf16 v[32:35], v[204:207], v[236:239], v[32:35]
  s_waitcnt vmcnt(18)
  v_mfma_f32_16x16x32_bf16 v[76:79], v[108:111], v[112:115], v[76:79]
  v_mfma_f32_16x16x32_bf16 v[80:83], v[108:111], v[116:119], v[80:83]
  buffer_load_dwordx4 v[216:219], v5, s[4:7], s28 offen
  v_mfma_f32_16x16x32_bf16 v[84:87], v[108:111], v[120:123], v[84:87]
  v_mfma_f32_16x16x32_bf16 v[88:91], v[108:111], v[124:127], v[88:91]
  buffer_load_dwordx4 v[220:223], v1, s[8:11], s29 offen offset:0
  v_mfma_f32_16x16x32_bf16 v[92:95], v[108:111], v[128:131], v[92:95]
  v_mfma_f32_16x16x32_bf16 v[56:59], v[104:107], v[112:115], v[56:59]
  buffer_load_dwordx4 v[224:227], v1, s[8:11], s29 offen offset:1024
  v_mfma_f32_16x16x32_bf16 v[60:63], v[104:107], v[116:119], v[60:63]
  v_mfma_f32_16x16x32_bf16 v[64:67], v[104:107], v[120:123], v[64:67]
  buffer_load_dwordx4 v[228:231], v1, s[8:11], s29 offen offset:2048
  v_mfma_f32_16x16x32_bf16 v[68:71], v[104:107], v[124:127], v[68:71]
  v_mfma_f32_16x16x32_bf16 v[72:75], v[104:107], v[128:131], v[72:75]
  buffer_load_dwordx4 v[232:235], v1, s[8:11], s29 offen offset:3072
  v_mfma_f32_16x16x32_bf16 v[36:39], v[100:103], v[112:115], v[36:39]
  v_mfma_f32_16x16x32_bf16 v[40:43], v[100:103], v[116:119], v[40:43]
  buffer_load_dwordx4 v[236:239], v6, s[8:11], s29 offen offset:0
  v_mfma_f32_16x16x32_bf16 v[44:47], v[100:103], v[120:123], v[44:47]
  v_mfma_f32_16x16x32_bf16 v[48:51], v[100:103], v[124:127], v[48:51]
  buffer_load_dwordx4 v[212:215], v4, s[4:7], s28 offen
  v_mfma_f32_16x16x32_bf16 v[52:55], v[100:103], v[128:131], v[52:55]
  v_mfma_f32_16x16x32_bf16 v[16:19], v[96:99], v[112:115], v[16:19]
  buffer_load_dwordx4 v[208:211], v3, s[4:7], s28 offen
  v_mfma_f32_16x16x32_bf16 v[20:23], v[96:99], v[116:119], v[20:23]
  v_mfma_f32_16x16x32_bf16 v[24:27], v[96:99], v[120:123], v[24:27]
  buffer_load_dwordx4 v[204:207], v2, s[4:7], s28 offen
  s_add_u32 s28, s28, 16384
  s_add_u32 s29, s29, 20480
  v_mfma_f32_16x16x32_bf16 v[28:31], v[96:99], v[124:127], v[28:31]
  v_mfma_f32_16x16x32_bf16 v[32:35], v[96:99], v[128:131], v[32:35]
  s_waitcnt vmcnt(18)
  v_mfma_f32_16x16x32_bf16 v[76:79], v[144:147], v[148:151], v[76:79]
  v_mfma_f32_16x16x32_bf16 v[80:83], v[144:147], v[152:155], v[80:83]
  buffer_load_dwordx4 v[108:111], v5, s[4:7], s28 offen
  v_mfma_f32_16x16x32_bf16 v[84:87], v[144:147], v[156:159], v[84:87]
  v_mfma_f32_16x16x32_bf16 v[88:91], v[144:147], v[160:163], v[88:91]
  buffer_load_dwordx4 v[112:115], v1, s[8:11], s29 offen offset:0
  v_mfma_f32_16x16x32_bf16 v[92:95], v[144:147], v[164:167], v[92:95]
  v_mfma_f32_16x16x32_bf16 v[56:59], v[140:143], v[148:151], v[56:59]
  buffer_load_dwordx4 v[116:119], v1, s[8:11], s29 offen offset:1024
  v_mfma_f32_16x16x32_bf16 v[60:63], v[140:143], v[152:155], v[60:63]
  v_mfma_f32_16x16x32_bf16 v[64:67], v[140:143], v[156:159], v[64:67]
  buffer_load_dwordx4 v[120:123], v1, s[8:11], s29 offen offset:2048
  v_mfma_f32_16x16x32_bf16 v[68:71], v[140:143], v[160:163], v[68:71]
  v_mfma_f32_16x16x32_bf16 v[72:75], v[140:143], v[164:167], v[72:75]
  buffer_load_dwordx4 v[124:127], v1, s[8:11], s29 offen offset:3072
  v_mfma_f32_16x16x32_bf16 v[36:39], v[136:139], v[148:151], v[36:39]
  v_mfma_f32_16x16x32_bf16 v[40:43], v[136:139], v[152:155], v[40:43]
  buffer_load_dwordx4 v[128:131], v6, s[8:11], s29 offen offset:0
  v_mfma_f32_16x16x32_bf16 v[44:47], v[136:139], v[156:159], v[44:47]
  v_mfma_f32_16x16x32_bf16 v[48:51], v[136:139], v[160:163], v[48:51]
  buffer_load_dwordx4 v[104:107], v4, s[4:7], s28 offen
  v_mfma_f32_16x16x32_bf16 v[52:55], v[136:139], v[164:167], v[52:55]
  v_mfma_f32_16x16x32_bf16 v[16:19], v[132:135], v[148:151], v[16:19]
  buffer_load_dwordx4 v[100:103], v3, s[4:7], s28 offen
  v_mfma_f32_16x16x32_bf16 v[20:23], v[132:135], v[152:155], v[20:23]
  v_mfma_f32_16x16x32_bf16 v[24:27], v[132:135], v[156:159], v[24:27]
  buffer_load_dwordx4 v[96:99], v2, s[4:7], s28 offen
  s_add_u32 s28, s28, 16384
  s_add_u32 s29, s29, 20480
  v_mfma_f32_16x16x32_bf16 v[28:31], v[132:135], v[160:163], v[28:31]
  v_mfma_f32_16x16x32_bf16 v[32:35], v[132:135], v[164:167], v[32:35]
  s_waitcnt vmcnt(18)
  v_mfma_f32_16x16x32_bf16 v[76:79], v[180:183], v[184:187], v[76:79]
  v_mfma_f32_16x16x32_bf16 v[80:83], v[180:183], v[188:191], v[80:83]
  buffer_load_dwordx4 v[144:147], v5, s[4:7], s28 offen
  v_mfma_f32_16x16x32_bf16 v[84:87], v[180:183], v[192:195], v[84:87]
  v_mfma_f32_16x16x32_bf16 v[88:91], v[180:183], v[196:199], v[88:91]
  buffer_load_dwordx4 v[148:151], v1, s[8:11], s29 offen offset:0
  v_mfma_f32_16x16x32_bf16 v[92:95], v[180:183], v[200:203], v[92:95]
  v_mfma_f32_16x16x32_bf16 v[56:59], v[176:179], v[184:187], v[56:59]
  buffer_load_dwordx4 v[152:155], v1, s[8:11], s29 offen offset:1024
  v_mfma_f32_16x16x32_bf16 v[60:63], v[176:179], v[188:191], v[60:63]
  v_mfma_f32_16x16x32_bf16 v[64:67], v[176:179], v[192:195], v[64:67]
  buffer_load_dwordx4 v[156:159], v1, s[8:11], s29 offen offset:2048
  v_mfma_f32_16x16x32_bf16 v[68:71], v[176:179], v[196:199], v[68:71]
  v_mfma_f32_16x16x32_bf16 v[72:75], v[176:179], v[200:203], v[72:75]
  buffer_load_dwordx4 v[160:163], v1, s[8:11], s29 offen offset:3072
  v_mfma_f32_16x16x32_bf16 v[36:39], v[172:175], v[184:187], v[36:39]
  v_mfma_f32_16x16x32_bf16 v[40:43], v[172:175], v[188:191], v[40:43]
  buffer_load_dwordx4 v[164:167], v6, s[8:11], s29 offen offset:0
  v_mfma_f32_16x16x32_bf16 v[44:47], v[172:175], v[192:195], v[44:47]
  v_mfma_f32_16x16x32_bf16 v[48:51], v[172:175], v[196:199], v[48:51]
  buffer_load_dwordx4 v[140:143], v4, s[4:7], s28 offen
  v_mfma_f32_16x16x32_bf16 v[52:55], v[172:175], v[200:203], v[52:55]
  v_mfma_f32_16x16x32_bf16 v[16:19], v[168:171], v[184:187], v[16:19]
  buffer_load_dwordx4 v[136:139], v3, s[4:7], s28 offen
  v_mfma_f32_16x16x32_bf16 v[20:23], v[168:171], v[188:191], v[20:23]
  v_mfma_f32_16x16x32_bf16 v[24:27], v[168:171], v[192:195], v[24:27]
  buffer_load_dwordx4 v[132:135], v2, s[4:7], s28 offen
  s_add_u32 s28, s28, 16384
  s_add_u32 s29, s29, 20480
  v_mfma_f32_16x16x32_bf16 v[28:31], v[168:171], v[196:199], v[28:31]
  v_mfma_f32_16x16x32_bf16 v[32:35], v[168:171], v[200:203], v[32:35]
  s_mov_b64 exec, 1
  ds_add_u32 v252, v253 offset:8
  s_mov_b64 exec, -1
  s_waitcnt vmcnt(18)
  v_mfma_f32_16x16x32_bf16 v[76:79], v[216:219], v[220:223], v[76:79]
  v_mfma_f32_16x16x32_bf16 v[80:83], v[216:219], v[224:227], v[80:83]
  v_mfma_f32_16x16x32_bf16 v[84:87], v[216:219], v[228:231], v[84:87]
  v_mfma_f32_16x16x32_bf16 v[88:91], v[216:219], v[232:235], v[88:91]
  v_mfma_f32_16x16x32_bf16 v[92:95], v[216:219], v[236:239], v[92:95]
  v_mfma_f32_16x16x32_bf16 v[56:59], v[212:215], v[220:223], v[56:59]
  v_mfma_f32_16x16x32_bf16 v[60:63], v[212:215], v[224:227], v[60:63]
  v_mfma_f32_16x16x32_bf16 v[64:67], v[212:215], v[228:231], v[64:67]
  v_mfma_f32_16x16x32_bf16 v[68:71], v[212:215], v[232:235], v[68:71]
  v_mfma_f32_16x16x32_bf16 v[72:75], v[212:215], v[236:239], v[72:75]
  v_mfma_f32_16x16x32_bf16 v[36:39], v[208:211], v[220:223], v[36:39]
  v_mfma_f32_16x16x32_bf16 v[40:43], v[208:211], v[224:227], v[40:43]
  v_mfma_f32_16x16x32_bf16 v[44:47], v[208:211], v[228:231], v[44:47]
  v_mfma_f32_16x16x32_bf16 v[48:51], v[208:211], v[232:235], v[48:51]
  v_mfma_f32_16x16x32_bf16 v[52:55], v[208:211], v[236:239], v[52:55]
  v_mfma_f32_16x16x32_bf16 v[16:19], v[204:207], v[220:223], v[16:19]
  v_mfma_f32_16x16x32_bf16 v[20:23], v[204:207], v[224:227], v[20:23]
  v_mfma_f32_16x16x32_bf16 v[24:27], v[204:207], v[228:231], v[24:27]
  v_mfma_f32_16x16x32_bf16 v[28:31], v[204:207], v[232:235], v[28:31]
  v_mfma_f32_16x16x32_bf16 v[32:35], v[204:207], v[236:239], v[32:35]
  s_waitcnt vmcnt(9)
  v_mfma_f32_16x16x32_bf16 v[76:79], v[108:111], v[112:115], v[76:79]
  v_mfma_f32_16x16x32_bf16 v[80:83], v[108:111], v[116:119], v[80:83]
  v_mfma_f32_16x16x32_bf16 v[84:87], v[108:111], v[120:123], v[84:87]
  v_mfma_f32_16x16x32_bf16 v[88:91], v[108:111], v[124:127], v[88:91]
  v_mfma_f32_16x16x32_bf16 v[92:95], v[108:111], v[128:131], v[92:95]
  v_mfma_f32_16x16x32_bf16 v[56:59], v[104:107], v[112:115], v[56:59]
  v_mfma_f32_16x16x32_bf16 v[60:63], v[104:107], v[116:119], v[60:63]
  v_mfma_f32_16x16x32_bf16 v[64:67], v[104:107], v[120:123], v[64:67]
  v_mfma_f32_16x16x32_bf16 v[68:71], v[104:107], v[124:127], v[68:71]
  v_mfma_f32_16x16x32_bf16 v[72:75], v[104:107], v[128:131], v[72:75]
  v_mfma_f32_16x16x32_bf16 v[36:39], v[100:103], v[112:115], v[36:39]
  v_mfma_f32_16x16x32_bf16 v[40:43], v[100:103], v[116:119], v[40:43]
  v_mfma_f32_16x16x32_bf16 v[44:47], v[100:103], v[120:123], v[44:47]
  v_mfma_f32_16x16x32_bf16 v[48:51], v[100:103], v[124:127], v[48:51]
  v_mfma_f32_16x16x32_bf16 v[52:55], v[100:103], v[128:131], v[52:55]
  v_mfma_f32_16x16x32_bf16 v[16:19], v[96:99], v[112:115], v[16:19]
  v_mfma_f32_16x16x32_bf16 v[20:23], v[96:99], v[116:119], v[20:23]
  v_mfma_f32_16x16x32_bf16 v[24:27], v[96:99], v[120:123], v[24:27]
  v_mfma_f32_16x16x32_bf16 v[28:31], v[96:99], v[124:127], v[28:31]
  v_mfma_f32_16x16x32_bf16 v[32:35], v[96:99], v[128:131], v[32:35]
  s_cmp_ge_u32 s3, 2
  s_cbranch_scc1 g2skip_30
  s_waitcnt vmcnt(0)
  v_mfma_f32_16x16x32_bf16 v[76:79], v[144:147], v[148:151], v[76:79]
  v_mfma_f32_16x16x32_bf16 v[80:83], v[144:147], v[152:155], v[80:83]
  v_mfma_f32_16x16x32_bf16 v[84:87], v[144:147], v[156:159], v[84:87]
  v_mfma_f32_16x16x32_bf16 v[88:91], v[144:147], v[160:163], v[88:91]
  v_mfma_f32_16x16x32_bf16 v[92:95], v[144:147], v[164:167], v[92:95]
  v_mfma_f32_16x16x32_bf16 v[56:59], v[140:143], v[148:151], v[56:59]
  v_mfma_f32_16x16x32_bf16 v[60:63], v[140:143], v[152:155], v[60:63]
  v_mfma_f32_16x16x32_bf16 v[64:67], v[140:143], v[156:159], v[64:67]
  v_mfma_f32_16x16x32_bf16 v[68:71], v[140:143], v[160:163], v[68:71]
  v_mfma_f32_16x16x32_bf16 v[72:75], v[140:143], v[164:167], v[72:75]
  v_mfma_f32_16x16x32_bf16 v[36:39], v[136:139], v[148:151], v[36:39]
  s_mov_b32 m0, s80
  s_nop 0
  ds_write_addtid_b32 v76 offset:0
  ds_write_addtid_b32 v77 offset:256
  v_mfma_f32_16x16x32_bf16 v[40:43], v[136:139], v[152:155], v[40:43]
  ds_write_addtid_b32 v78 offset:512
  ds_write_addtid_b32 v79 offset:768
  v_mfma_f32_16x16x32_bf16 v[44:47], v[136:139], v[156:159], v[44:47]
  ds_write_addtid_b32 v80 offset:1024
  ds_write_addtid_b32 v81 offset:1280
  v_mfma_f32_16x16x32_bf16 v[48:51], v[136:139], v[160:163], v[48:51]
  ds_write_addtid_b32 v82 offset:1536
  ds_write_addtid_b32 v83 offset:1792
  v_mfma_f32_16x16x32_bf16 v[52:55], v[136:139], v[164:167], v[52:55]
  ds_write_addtid_b32 v84 offset:2048
  ds_write_addtid_b32 v85 offset:2304
  v_mfma_f32_16x16x32_bf16 v[16:19], v[132:135], v[148:151], v[16:19]
  ds_write_addtid_b32 v86 offset:2560
  ds_write_addtid_b32 v87 offset:2816
  v_mfma_f32_16x16x32_bf16 v[20:23], v[132:135], v[152:155], v[20:23]
  ds_write_addtid_b32 v88 offset:3072
  ds_write_addtid_b32 v89 offset:3328
  v_mfma_f32_16x16x32_bf16 v[24:27], v[132:135], v[156:159], v[24:27]
  ds_write_addtid_b32 v90 offset:3584
  ds_write_addtid_b32 v91 offset:3840
  v_mfma_f32_16x16x32_bf16 v[28:31], v[132:135], v[160:163], v[28:31]
  ds_write_addtid_b32 v92 offset:4096
  ds_write_addtid_b32 v93 offset:4352
  v_mfma_f32_16x16x32_bf16 v[32:35], v[132:135], v[164:167], v[32:35]
  ds_write_addtid_b32 v94 offset:4608
  ds_write_addtid_b32 v95 offset:4864
  s_mov_b32 m0, s79
  s_nop 0
  ds_write_addtid_b32 v56 offset:0
  ds_write_addtid_b32 v57 offset:256
  ds_write_addtid_b32 v58 offset:512
  ds_write_addtid_b32 v59 offset:768
  ds_write_addtid_b32 v60 offset:1024
  ds_write_addtid_b32 v61 offset:1280
  ds_write_addtid_b32 v62 offset:1536
  ds_write_addtid_b32 v63 offset:1792
  ds_write_addtid_b32 v64 offset:2048
  ds_write_addtid_b32 v65 offset:2304
  ds_write_addtid_b32 v66 offset:2560
  ds_write_addtid_b32 v67 offset:2816
  ds_write_addtid_b32 v68 offset:3072
  ds_write_addtid_b32 v69 offset:3328
  ds_write_addtid_b32 v70 offset:3584
  ds_write_addtid_b32 v71 offset:3840
  ds_write_addtid_b32 v72 offset:4096
  ds_write_addtid_b32 v73 offset:4352
  ds_write_addtid_b32 v74 offset:4608
  ds_write_addtid_b32 v75 offset:4864
  s_mov_b32 m0, s78
  s_nop 0
  ds_write_addtid_b32 v36 offset:0
  ds_write_addtid_b32 v37 offset:256
  ds_write_addtid_b32 v38 offset:512
  ds_write_addtid_b32 v39 offset:768
  ds_write_addtid_b32 v40 offset:1024
  ds_write_addtid_b32 v41 offset:1280
  ds_write_addtid_b32 v42 offset:1536
  ds_write_addtid_b32 v43 offset:1792
  ds_write_addtid_b32 v44 offset:2048
  ds_write_addtid_b32 v45 offset:2304
  ds_write_addtid_b32 v46 offset:2560
  ds_write_addtid_b32 v47 offset:2816
  ds_write_addtid_b32 v48 offset:3072
  ds_write_addtid_b32 v49 offset:3328
  ds_write_addtid_b32 v50 offset:3584
  ds_write_addtid_b32 v51 offset:3840
  ds_write_addtid_b32 v52 offset:4096
  ds_write_addtid_b32 v53 offset:4352
  ds_write_addtid_b32 v54 offset:4608
  ds_write_addtid_b32 v55 offset:4864
  s_branch g2fin_31
g2skip_30:
  s_waitcnt vmcnt(0)
  s_nop 7
  s_mov_b32 m0, s80
  s_nop 0
  ds_write_addtid_b32 v76 offset:0
  ds_write_addtid_b32 v77 offset:256
  ds_write_addtid_b32 v78 offset:512
  ds_write_addtid_b32 v79 offset:768
  ds_write_addtid_b32 v80 offset:1024
  ds_write_addtid_b32 v81 offset:1280
  ds_write_addtid_b32 v82 offset:1536
  ds_write_addtid_b32 v83 offset:1792
  ds_write_addtid_b32 v84 offset:2048
  ds_write_addtid_b32 v85 offset:2304
  ds_write_addtid_b32 v86 offset:2560
  ds_write_addtid_b32 v87 offset:2816
  ds_write_addtid_b32 v88 offset:3072
  ds_write_addtid_b32 v89 offset:3328
  ds_write_addtid_b32 v90 offset:3584
  ds_write_addtid_b32 v91 offset:3840
  ds_write_addtid_b32 v92 offset:4096
  ds_write_addtid_b32 v93 offset:4352
  ds_write_addtid_b32 v94 offset:4608
  ds_write_addtid_b32 v95 offset:4864
  s_mov_b32 m0, s79
  s_nop 0
  ds_write_addtid_b32 v56 offset:0
  ds_write_addtid_b32 v57 offset:256
  ds_write_addtid_b32 v58 offset:512
  ds_write_addtid_b32 v59 offset:768
  ds_write_addtid_b32 v60 offset:1024
  ds_write_addtid_b32 v61 offset:1280
  ds_write_addtid_b32 v62 offset:1536
  ds_write_addtid_b32 v63 offset:1792
  ds_write_addtid_b32 v64 offset:2048
  ds_write_addtid_b32 v65 offset:2304
  ds_write_addtid_b32 v66 offset:2560
  ds_write_addtid_b32 v67 offset:2816
  ds_write_addtid_b32 v68 offset:3072
  ds_write_addtid_b32 v69 offset:3328
  ds_write_addtid_b32 v70 offset:3584
  ds_write_addtid_b32 v71 offset:3840
  ds_write_addtid_b32 v72 offset:4096
  ds_write_addtid_b32 v73 offset:4352
  ds_write_addtid_b32 v74 offset:4608
  ds_write_addtid_b32 v75 offset:4864
  s_mov_b32 m0, s78
  s_nop 0
  ds_write_addtid_b32 v36 offset:0
  ds_write_addtid_b32 v37 offset:256
  ds_write_addtid_b32 v38 offset:512
  ds_write_addtid_b32 v39 offset:768
  ds_write_addtid_b32 v40 offset:1024
  ds_write_addtid_b32 v41 offset:1280
  ds_write_addtid_b32 v42 offset:1536
  ds_write_addtid_b32 v43 offset:1792
  ds_write_addtid_b32 v44 offset:2048
  ds_write_addtid_b32 v45 offset:2304
  ds_write_addtid_b32 v46 offset:2560
  ds_write_addtid_b32 v47 offset:2816
  ds_write_addtid_b32 v48 offset:3072
  ds_write_addtid_b32 v49 offset:3328
  ds_write_addtid_b32 v50 offset:3584
  ds_write_addtid_b32 v51 offset:3840
  ds_write_addtid_b32 v52 offset:4096
  ds_write_addtid_b32 v53 offset:4352
  ds_write_addtid_b32 v54 offset:4608
  ds_write_addtid_b32 v55 offset:4864
g2fin_31:
  v_sub_f32 v8, 1.0, v8
  v_sub_f32 v9, 1.0, v9
  v_sub_f32 v10, 1.0, v10
  v_sub_f32 v11, 1.0, v11
  s_waitcnt lgkmcnt(0)
  s_mov_b64 exec, 1
  ds_add_u32 v252, v253 offset:12
  s_mov_b64 exec, -1
gs_32:
  ds_read_b32 v250, v252 offset:12
  s_waitcnt lgkmcnt(0)
  v_readfirstlane_b32 s26, v250
  s_cmp_lt_u32 s26, 4
  s_cbranch_scc1 gs_32
  ds_read2st64_b32 v[96:97], v14 offset0:0 offset1:1
  ds_read2st64_b32 v[98:99], v14 offset0:2 offset1:3
  ds_read2st64_b32 v[116:117], v14 offset0:20 offset1:21
  ds_read2st64_b32 v[118:119], v14 offset0:22 offset1:23
  ds_read2st64_b32 v[136:137], v14 offset0:40 offset1:41
  ds_read2st64_b32 v[138:139], v14 offset0:42 offset1:43
  ds_read2st64_b32 v[100:101], v14 offset0:4 offset1:5
  ds_read2st64_b32 v[102:103], v14 offset0:6 offset1:7
  ds_read2st64_b32 v[120:121], v14 offset0:24 offset1:25
  ds_read2st64_b32 v[122:123], v14 offset0:26 offset1:27
  ds_read2st64_b32 v[140:141], v14 offset0:44 offset1:45
  ds_read2st64_b32 v[142:143], v14 offset0:46 offset1:47
  s_waitcnt lgkmcnt(6)
  ds_read2st64_b32 v[104:105], v14 offset0:8 offset1:9
  ds_read2st64_b32 v[106:107], v14 offset0:10 offset1:11
  ds_read2st64_b32 v[124:125], v14 offset0:28 offset1:29
  ds_read2st64_b32 v[126:127], v14 offset0:30 offset1:31
  ds_read2st64_b32 v[144:145], v14 offset0:48 offset1:49
  ds_read2st64_b32 v[146:147], v14 offset0:50 offset1:51
  v_pk_add_f32 v[16:17], v[16:17], v[96:97]
  v_pk_add_f32 v[116:117], v[116:117], v[136:137]
  v_pk_add_f32 v[18:19], v[18:19], v[98:99]
  v_pk_add_f32 v[118:119], v[118:119], v[138:139]
  v_pk_add_f32 v[16:17], v[16:17], v[116:117]
  v_pk_add_f32 v[18:19], v[18:19], v[118:119]
  s_waitcnt lgkmcnt(6)
  ds_read2st64_b32 v[108:109], v14 offset0:12 offset1:13
  ds_read2st64_b32 v[110:111], v14 offset0:14 offset1:15
  ds_read2st64_b32 v[128:129], v14 offset0:32 offset1:33
  ds_read2st64_b32 v[130:131], v14 offset0:34 offset1:35
  ds_read2st64_b32 v[148:149], v14 offset0:52 offset1:53
  ds_read2st64_b32 v[150:151], v14 offset0:54 offset1:55
  v_pk_add_f32 v[20:21], v[20:21], v[100:101]
  v_pk_add_f32 v[120:121], v[120:121], v[140:141]
  v_pk_add_f32 v[22:23], v[22:23], v[102:103]
  v_pk_add_f32 v[122:123], v[122:123], v[142:143]
  v_pk_add_f32 v[20:21], v[20:21], v[120:121]
  v_pk_add_f32 v[22:23], v[22:23], v[122:123]
  s_waitcnt lgkmcnt(6)
  ds_read2st64_b32 v[112:113], v14 offset0:16 offset1:17
  ds_read2st64_b32 v[114:115], v14 offset0:18 offset1:19
  ds_read2st64_b32 v[132:133], v14 offset0:36 offset1:37
  ds_read2st64_b32 v[134:135], v14 offset0:38 offset1:39
  ds_read2st64_b32 v[152:153], v14 offset0:56 offset1:57
  ds_read2st64_b32 v[154:155], v14 offset0:58 offset1:59
  v_pk_add_f32 v[24:25], v[24:25], v[104:105]
  v_pk_add_f32 v[124:125], v[124:125], v[144:145]
  v_pk_add_f32 v[26:27], v[26:27], v[106:107]
  v_pk_add_f32 v[126:127], v[126:127], v[146:147]
  v_pk_add_f32 v[24:25], v[24:25], v[124:125]
  v_pk_add_f32 v[26:27], v[26:27], v[126:127]
  s_waitcnt lgkmcnt(6)
  v_pk_add_f32 v[28:29], v[28:29], v[108:109]
  v_pk_add_f32 v[128:129], v[128:129], v[148:149]
  v_pk_add_f32 v[30:31], v[30:31], v[110:111]
  v_pk_add_f32 v[130:131], v[130:131], v[150:151]
  v_pk_add_f32 v[28:29], v[28:29], v[128:129]
  v_pk_add_f32 v[30:31], v[30:31], v[130:131]
  s_waitcnt lgkmcnt(0)
  v_pk_add_f32 v[32:33], v[32:33], v[112:113]
  v_pk_add_f32 v[132:133], v[132:133], v[152:153]
  v_pk_add_f32 v[34:35], v[34:35], v[114:115]
  v_pk_add_f32 v[134:135], v[134:135], v[154:155]
  v_pk_add_f32 v[32:33], v[32:33], v[132:133]
  v_pk_add_f32 v[34:35], v[34:35], v[134:135]
  s_barrier
  ds_read_b128 v[160:163], v15 offset:0
  ds_read_b128 v[164:167], v15 offset:1024
  ds_read_b128 v[168:171], v15 offset:2048
  ds_read_b128 v[172:175], v15 offset:3072
  ds_read_b128 v[176:179], v15 offset:4096
  s_waitcnt lgkmcnt(4)
  v_pk_fma_f32 v[16:17], v[16:17], v[8:9], v[160:161]
  v_pk_fma_f32 v[18:19], v[18:19], v[10:11], v[162:163]
  s_waitcnt lgkmcnt(3)
  v_pk_fma_f32 v[20:21], v[20:21], v[8:9], v[164:165]
  v_pk_fma_f32 v[22:23], v[22:23], v[10:11], v[166:167]
  s_waitcnt lgkmcnt(2)
  v_pk_fma_f32 v[24:25], v[24:25], v[8:9], v[168:169]
  v_pk_fma_f32 v[26:27], v[26:27], v[10:11], v[170:171]
  s_waitcnt lgkmcnt(1)
  v_pk_fma_f32 v[28:29], v[28:29], v[8:9], v[172:173]
  v_pk_fma_f32 v[30:31], v[30:31], v[10:11], v[174:175]
  v_cvt_pk_bf16_f32 v40, v16, v20
  v_cvt_pk_bf16_f32 v41, v24, v28
  buffer_store_dwordx2 v[40:41], v12, s[16:19], s30 offen offset:0 sc0 sc1 nt
  v_cvt_pk_bf16_f32 v42, v17, v21
  v_cvt_pk_bf16_f32 v43, v25, v29
  buffer_store_dwordx2 v[42:43], v12, s[16:19], s30 offen offset:1280 sc0 sc1 nt
  v_cvt_pk_bf16_f32 v44, v18, v22
  v_cvt_pk_bf16_f32 v45, v26, v30
  buffer_store_dwordx2 v[44:45], v12, s[16:19], s30 offen offset:2560 sc0 sc1 nt
  v_cvt_pk_bf16_f32 v46, v19, v23
  v_cvt_pk_bf16_f32 v47, v27, v31
  buffer_store_dwordx2 v[46:47], v12, s[16:19], s30 offen offset:3840 sc0 sc1 nt
  s_waitcnt lgkmcnt(0)
  v_pk_fma_f32 v[32:33], v[32:33], v[8:9], v[176:177]
  v_pk_fma_f32 v[34:35], v[34:35], v[10:11], v[178:179]
  v_cvt_pk_bf16_f32 v48, v32, v33
  buffer_store_short v48, v13, s[16:19], s30 offen offset:0
  buffer_store_short_d16_hi v48, v13, s[16:19], s30 offen offset:1280
  v_cvt_pk_bf16_f32 v49, v34, v35
  buffer_store_short v49, v13, s[16:19], s30 offen offset:2560
  buffer_store_short_d16_hi v49, v13, s[16:19], s30 offen offset:3840
  s_endpgm
conv_27:
  s_setprio 2
  s_sub_u32 s33, s3, 4
  s_lshl_b32 s32, s33, 10
  v_lshl_add_u32 v8, v0, 4, s32
  s_waitcnt lgkmcnt(0)
  s_mov_b32 s12, s70
  s_mov_b32 s13, s71
  s_mov_b32 s14, 0x10000000
  s_mov_b32 s15, 0x00020000
  s_mul_i32 s26, s34, 4224
  s_add_u32 s26, s26, 0xe00000
  s_lshl_b32 s27, s34, 12
  s_add_u32 s27, s27, 0xb00000
  buffer_load_dwordx4 v[16:19], v8, s[12:15], s26 offen
  buffer_load_dwordx2 v[20:21], v8, s[12:15], s26 offen offset:16
  buffer_load_dwordx4 v[22:25], v8, s[12:15], s27 offen
  v_mov_b32 v2, 157952
  v_mov_b32 v46, 0
  v_mov_b32 v47, 0
  v_min_u32 v3, 59, v0
  v_lshlrev_b32 v3, 3, v3
  s_mul_i32 s26, s33, 4160
  v_and_b32 v4, 7, v0
  v_lshl_add_u32 v4, v4, 3, s26
  ds_write_b64 v2, v[46:47]
  ds_write_b64 v2, v[46:47] offset:8
  ds_write_b64 v3, v[46:47] offset:16640
  ds_write_b64 v4, v[46:47] offset:4096
  ds_write_b64 v3, v[46:47] offset:37888
  ds_write_b64 v4, v[46:47] offset:25344
  ds_write_b64 v3, v[46:47] offset:59136
  ds_write_b64 v4, v[46:47] offset:46592
  s_waitcnt lgkmcnt(0)
  s_barrier
  v_and_b32 v1, 15, v0
  v_lshrrev_b32 v15, 4, v0
  s_lshr_b32 s26, s21, 2
  s_lshl_b32 s26, s26, 6
  s_and_b32 s27, s21, 3
  s_add_u32 s26, s26, s27
  s_add_u32 s26, s26, 512
  v_lshl_add_u32 v7, v1, 2, s26
  s_mov_b32 s72, s62
  s_mov_b32 s73, s63
  s_mov_b32 s74, 0x500
  s_mov_b32 s75, 0x00020000
  v_lshlrev_b32 v13, 12, v7
  v_lshlrev_b32 v10, 1, v7
  s_lshl_b32 s26, s20, 2
  s_add_u32 s26, s26, s33
  s_lshl_b32 s86, s26, 5
  s_add_u32 s86, s86, 18874368
  s_lshl_b32 s87, s26, 6
  s_add_u32 s87, s87, 22020096
  v_mov_b32 v3, 1
  v_lshl_add_u32 v13, v15, 3, v13
  s_lshl_b32 s26, s21, 18
  v_lshlrev_b32 v12, 14, v1
  v_add_u32 v12, s26, v12
  v_lshl_add_u32 v12, v15, 3, v12
  s_mul_i32 s26, s33, 5120
  s_add_u32 s26, s26, 63744
  v_lshl_add_u32 v14, v0, 4, s26
  s_lshl_b32 s26, s33, 7
  s_sub_u32 s26, 384, s26
  v_lshlrev_b32 v6, 5, v1
  v_lshl_add_u32 v6, v15, 4, v6
  v_add_u32 v6, s26, v6
  v_add_u32 v6, 16640, v6
  v_sub_u32 v4, 3, v1
  v_and_b32 v4, 3, v4
  v_mul_u32_u24 v5, 4160, v4
  v_lshrrev_b32 v4, 2, v1
  v_sub_u32 v7, 3, v4
  v_lshl_add_u32 v5, v7, 3, v5
  v_lshl_add_u32 v5, v15, 4, v5
  v_add_u32 v5, s26, v5
  v_lshlrev_b32 v11, 7, v4
  v_lshl_add_u32 v11, v15, 5, v11
  v_and_b32 v4, 3, v0
  v_lshl_add_u32 v11, v4, 3, v11
  v_add_u32 v11, s32, v11
  s_lshl_b32 s26, s33, 11
  s_add_u32 s26, s26, 63744
  v_lshl_add_u32 v9, v0, 4, s26
  s_lshl_b32 s81, s33, 13
  s_add_u32 s81, s81, 63744
  s_mov_b32 m0, s81
  s_mov_b32 s83, 4
  s_mov_b32 s84, 0
  s_mov_b32 s85, 8
  s_mov_b64 s[88:89], 0
  s_mov_b32 s27, 18874368
  s_waitcnt vmcnt(0)
  ds_write_b128 v8, v[22:25] offset:17120
  v_alignbit_b32 v26, v17, v16, 16
  v_alignbit_b32 v27, v18, v17, 16
  v_alignbit_b32 v28, v19, v18, 16
  v_alignbit_b32 v29, v20, v19, 16
  ds_write_b128 v8, v[16:19] offset:0
  v_mov_b32 v30, v17
  v_mov_b32 v31, v18
  v_mov_b32 v32, v19
  v_mov_b32 v33, v20
  ds_write_b128 v8, v[26:29] offset:4160
  v_alignbit_b32 v34, v18, v17, 16
  v_alignbit_b32 v35, v19, v18, 16
  v_alignbit_b32 v36, v20, v19, 16
  v_alignbit_b32 v37, v21, v20, 16
  ds_write_b128 v8, v[30:33] offset:8320
  ds_write_b128 v8, v[34:37] offset:12480
  s_mov_b64 exec, 1
  ds_add_u32 v2, v3 offset:0
  s_mov_b64 exec, -1
cs_33:
  ds_read_b32 v4, v2 offset:0
  s_waitcnt lgkmcnt(0)
  v_readfirstlane_b32 s26, v4
  s_cmp_lt_u32 s26, s83
  s_cbranch_scc1 cs_33
  ds_read_b64 v[112:113], v5 offset:3648
  ds_read_b64 v[114:115], v5 offset:3656
  ds_read_b64 v[116:117], v5 offset:3584
  ds_read_b64 v[118:119], v5 offset:3592
  ds_read_b128 v[104:107], v6 offset:3648
  ds_read_b128 v[108:111], v6 offset:3584
  ds_read_b128 v[96:99], v6 offset:3136
  ds_read_b128 v[100:103], v6 offset:3072
  ds_read_b128 v[88:91], v6 offset:2624
  ds_read_b128 v[92:95], v6 offset:2560
  ds_read_b128 v[80:83], v6 offset:2112
  ds_read_b128 v[84:87], v6 offset:2048
  ds_read_b128 v[72:75], v6 offset:1600
  ds_read_b128 v[76:79], v6 offset:1536
  ds_read_b128 v[64:67], v6 offset:1088
  ds_read_b128 v[68:71], v6 offset:1024
  ds_read_b128 v[56:59], v6 offset:576
  ds_read_b128 v[60:63], v6 offset:512
  ds_read_b128 v[48:51], v6 offset:64
  ds_read_b128 v[52:55], v6 offset:0
cv_34:
  s_waitcnt lgkmcnt(4)
  v_mfma_f32_16x16x32_bf16 v[36:39], v[88:91], v[112:115], 0
  ds_read_b64 v[120:121], v5 offset:3136
  ds_read_b64 v[122:123], v5 offset:3144
  ds_read_b64 v[124:125], v5 offset:3072
  v_mfma_f32_16x16x32_bf16 v[32:35], v[80:83], v[112:115], 0
  ds_read_b64 v[126:127], v5 offset:3080
  v_mfma_f32_16x16x32_bf16 v[28:31], v[72:75], v[112:115], 0
  v_mfma_f32_16x16x32_bf16 v[24:27], v[64:67], v[112:115], 0
  ds_read_b32 v4, v2
  ds_read_b64 v[128:129], v5 offset:2624
  ds_read_b64 v[130:131], v5 offset:2632
  v_mfma_f32_16x16x32_bf16 v[40:43], v[96:99], v[112:115], 0
  ds_read_b64 v[132:133], v5 offset:2560
  ds_read_b64 v[134:135], v5 offset:2568
  v_mfma_f32_16x16x32_bf16 v[44:47], v[104:107], v[112:115], 0
  s_waitcnt lgkmcnt(12)
  v_mfma_f32_16x16x32_bf16 v[20:23], v[56:59], v[112:115], 0
  s_waitcnt lgkmcnt(10)
  v_mfma_f32_16x16x32_bf16 v[16:19], v[48:51], v[112:115], 0
  s_waitcnt lgkmcnt(9)
  v_mfma_f32_16x16x32_bf16 v[16:19], v[52:55], v[116:119], v[16:19]
  s_waitcnt lgkmcnt(4)
  v_readfirstlane_b32 s26, v4
  s_cmp_ge_u32 s26, s83
  s_cbranch_scc1 ok_35
sp_36:
  ds_read_b32 v4, v2 offset:0
  s_waitcnt lgkmcnt(0)
  v_readfirstlane_b32 s26, v4
  s_cmp_lt_u32 s26, s83
  s_cbranch_scc1 sp_36
ok_35:
  ds_read_b128 v[144:147], v9 offset:0
  v_mfma_f32_16x16x32_bf16 v[20:23], v[60:63], v[116:119], v[20:23]
  ds_read_b128 v[148:151], v9 offset:8192
  ds_read_b128 v[152:155], v9 offset:16384
  ds_read_b128 v[156:159], v9 offset:24576
  v_mfma_f32_16x16x32_bf16 v[24:27], v[68:71], v[116:119], v[24:27]
  ds_read_b128 v[160:163], v9 offset:1024
  ds_read_b128 v[164:167], v9 offset:9216
  ds_read_b128 v[168:171], v9 offset:17408
  v_mfma_f32_16x16x32_bf16 v[28:31], v[76:79], v[116:119], v[28:31]
  ds_read_b128 v[172:175], v9 offset:25600
  ds_read_b64 v[136:137], v5 offset:2112
  ds_read_b64 v[138:139], v5 offset:2120
  v_mfma_f32_16x16x32_bf16 v[32:35], v[84:87], v[116:119], v[32:35]
  ds_read_b64 v[140:141], v5 offset:2048
  ds_read_b64 v[142:143], v5 offset:2056
  s_waitcnt lgkmcnt(10)
  v_add_f32 v144, v144, v148
  v_mfma_f32_16x16x32_bf16 v[36:39], v[92:95], v[116:119], v[36:39]
  v_add_f32 v145, v145, v149
  v_add_f32 v146, v146, v150
  v_add_f32 v147, v147, v151
  v_mfma_f32_16x16x32_bf16 v[40:43], v[100:103], v[116:119], v[40:43]
  s_waitcnt lgkmcnt(8)
  v_add_f32 v152, v152, v156
  v_add_f32 v153, v153, v157
  v_mfma_f32_16x16x32_bf16 v[44:47], v[108:111], v[116:119], v[44:47]
  v_add_f32 v154, v154, v158
  v_add_f32 v155, v155, v159
  v_mfma_f32_16x16x32_bf16 v[20:23], v[48:51], v[120:123], v[20:23]
  v_add_f32 v144, v144, v152
  v_add_f32 v145, v145, v153
  v_add_f32 v146, v146, v154
  v_mfma_f32_16x16x32_bf16 v[24:27], v[56:59], v[120:123], v[24:27]
  v_add_f32 v147, v147, v155
  v_cvt_pk_bf16_f32 v176, v144, v145
  v_mfma_f32_16x16x32_bf16 v[28:31], v[64:67], v[120:123], v[28:31]
  v_cvt_pk_bf16_f32 v177, v146, v147
  v_min_u32 v176, -2, v176
  v_min_u32 v177, -2, v177
  v_mfma_f32_16x16x32_bf16 v[32:35], v[72:75], v[120:123], v[32:35]
  s_waitcnt lgkmcnt(6)
  v_add_f32 v160, v160, v164
  v_add_f32 v161, v161, v165
  v_mfma_f32_16x16x32_bf16 v[36:39], v[80:83], v[120:123], v[36:39]
  s_mov_b64 exec, 1
  ds_add_u32 v2, v3 offset:4
  s_mov_b64 exec, -1
  v_add_f32 v162, v162, v166
  v_mfma_f32_16x16x32_bf16 v[40:43], v[88:91], v[120:123], v[40:43]
  v_add_f32 v163, v163, v167
  s_waitcnt lgkmcnt(5)
  v_add_f32 v168, v168, v172
  v_add_f32 v169, v169, v173
  v_mfma_f32_16x16x32_bf16 v[44:47], v[96:99], v[120:123], v[44:47]
  v_add_f32 v170, v170, v174
  v_add_f32 v171, v171, v175
  v_mfma_f32_16x16x32_bf16 v[20:23], v[52:55], v[124:127], v[20:23]
  v_add_f32 v160, v160, v168
  v_add_f32 v161, v161, v169
  v_mfma_f32_16x16x32_bf16 v[24:27], v[60:63], v[124:127], v[24:27]
  v_add_f32 v162, v162, v170
  v_add_f32 v163, v163, v171
  v_cvt_pk_bf16_f32 v178, v160, v161
  v_mfma_f32_16x16x32_bf16 v[28:31], v[68:71], v[124:127], v[28:31]
  v_cvt_pk_bf16_f32 v179, v162, v163
  v_min_u32 v178, -2, v178
  v_mfma_f32_16x16x32_bf16 v[32:35], v[76:79], v[124:127], v[32:35]
  v_min_u32 v179, -2, v179
  ds_read_b64 v[112:113], v5 offset:1600
  ds_read_b64 v[114:115], v5 offset:1608
  v_mfma_f32_16x16x32_bf16 v[36:39], v[84:87], v[124:127], v[36:39]
  ds_read_b64 v[116:117], v5 offset:1536
  ds_read_b64 v[118:119], v5 offset:1544
  s_mov_b64 exec, s[88:89]
  buffer_store_dwordx2 v[176:177], v11, s[12:15], s27 offen offset:0 sc1
  buffer_store_dwordx2 v[178:179], v11, s[12:15], s27 offen offset:512 sc1
  s_mov_b64 exec, -1
  v_mfma_f32_16x16x32_bf16 v[40:43], v[92:95], v[124:127], v[40:43]
  v_mfma_f32_16x16x32_bf16 v[44:47], v[100:103], v[124:127], v[44:47]
  v_mfma_f32_16x16x32_bf16 v[24:27], v[48:51], v[128:131], v[24:27]
  ds_read_b32 v4, v2 offset:4
  ds_read_b64 v[120:121], v5 offset:1088
  ds_read_b64 v[122:123], v5 offset:1096
  v_mfma_f32_16x16x32_bf16 v[28:31], v[56:59], v[128:131], v[28:31]
  ds_read_b64 v[124:125], v5 offset:1024
  ds_read_b64 v[126:127], v5 offset:1032
  s_waitcnt lgkmcnt(4)
  v_readfirstlane_b32 s26, v4
  s_cmp_ge_u32 s26, s85
  s_cbranch_scc1 ok_37
sp_38:
  ds_read_b32 v4, v2 offset:4
  s_waitcnt lgkmcnt(0)
  v_readfirstlane_b32 s26, v4
  s_cmp_lt_u32 s26, s85
  s_cbranch_scc1 sp_38
ok_37:
  v_mfma_f32_16x16x32_bf16 v[32:35], v[64:67], v[128:131], v[32:35]
  ds_write_addtid_b32 v16 offset:0
  v_mfma_f32_16x16x32_bf16 v[36:39], v[72:75], v[128:131], v[36:39]
  ds_write_addtid_b32 v17 offset:256
  ds_write_addtid_b32 v18 offset:512
  v_mfma_f32_16x16x32_bf16 v[40:43], v[80:83], v[128:131], v[40:43]
  ds_write_addtid_b32 v19 offset:768
  v_mfma_f32_16x16x32_bf16 v[44:47], v[88:91], v[128:131], v[44:47]
  ds_read_b128 v[104:107], v6 offset:24896
  ds_read_b128 v[108:111], v6 offset:24832
  ds_write_addtid_b32 v20 offset:1024
  v_mfma_f32_16x16x32_bf16 v[24:27], v[52:55], v[132:135], v[24:27]
  ds_write_addtid_b32 v21 offset:1280
  v_mfma_f32_16x16x32_bf16 v[28:31], v[60:63], v[132:135], v[28:31]
  ds_write_addtid_b32 v22 offset:1536
  ds_write_addtid_b32 v23 offset:1792
  v_mfma_f32_16x16x32_bf16 v[32:35], v[68:71], v[132:135], v[32:35]
  ds_read_b128 v[96:99], v6 offset:24384
  ds_read_b128 v[100:103], v6 offset:24320
  v_mfma_f32_16x16x32_bf16 v[36:39], v[76:79], v[132:135], v[36:39]
  v_mfma_f32_16x16x32_bf16 v[40:43], v[84:87], v[132:135], v[40:43]
  v_mfma_f32_16x16x32_bf16 v[44:47], v[92:95], v[132:135], v[44:47]
  v_mfma_f32_16x16x32_bf16 v[28:31], v[48:51], v[136:139], v[28:31]
  ds_read_b64 v[128:129], v5 offset:576
  ds_read_b64 v[130:131], v5 offset:584
  ds_read_b64 v[132:133], v5 offset:512
  v_mfma_f32_16x16x32_bf16 v[32:35], v[56:59], v[136:139], v[32:35]
  ds_read_b64 v[134:135], v5 offset:520
  ds_write_addtid_b32 v24 offset:2048
  v_mfma_f32_16x16x32_bf16 v[36:39], v[64:67], v[136:139], v[36:39]
  ds_write_addtid_b32 v25 offset:2304
  ds_write_addtid_b32 v26 offset:2560
  v_mfma_f32_16x16x32_bf16 v[40:43], v[72:75], v[136:139], v[40:43]
  ds_write_addtid_b32 v27 offset:2816
  v_mfma_f32_16x16x32_bf16 v[44:47], v[80:83], v[136:139], v[44:47]
  ds_read_b128 v[88:91], v6 offset:23872
  ds_read_b128 v[92:95], v6 offset:23808
  v_mfma_f32_16x16x32_bf16 v[28:31], v[52:55], v[140:143], v[28:31]
  v_mfma_f32_16x16x32_bf16 v[32:35], v[60:63], v[140:143], v[32:35]
  v_mfma_f32_16x16x32_bf16 v[36:39], v[68:71], v[140:143], v[36:39]
  v_mfma_f32_16x16x32_bf16 v[40:43], v[76:79], v[140:143], v[40:43]
  v_mfma_f32_16x16x32_bf16 v[44:47], v[84:87], v[140:143], v[44:47]
  v_mfma_f32_16x16x32_bf16 v[32:35], v[48:51], v[112:115], v[32:35]
  ds_read_b64 v[136:137], v5 offset:64
  ds_read_b64 v[138:139], v5 offset:72
  ds_read_b64 v[140:141], v5 offset:0
  v_mfma_f32_16x16x32_bf16 v[36:39], v[56:59], v[112:115], v[36:39]
  ds_read_b64 v[142:143], v5 offset:8
  ds_write_addtid_b32 v28 offset:3072
  v_mfma_f32_16x16x32_bf16 v[40:43], v[64:67], v[112:115], v[40:43]
  ds_write_addtid_b32 v29 offset:3328
  ds_write_addtid_b32 v30 offset:3584
  v_mfma_f32_16x16x32_bf16 v[44:47], v[72:75], v[112:115], v[44:47]
  ds_write_addtid_b32 v31 offset:3840
  v_mfma_f32_16x16x32_bf16 v[32:35], v[52:55], v[116:119], v[32:35]
  ds_read_b128 v[80:83], v6 offset:23360
  ds_read_b128 v[84:87], v6 offset:23296
  v_mfma_f32_16x16x32_bf16 v[36:39], v[60:63], v[116:119], v[36:39]
  v_mfma_f32_16x16x32_bf16 v[40:43], v[68:71], v[116:119], v[40:43]
  v_mfma_f32_16x16x32_bf16 v[44:47], v[76:79], v[116:119], v[44:47]
  s_waitcnt lgkmcnt(15)
  v_mfma_f32_16x16x32_bf16 v[36:39], v[48:51], v[120:123], v[36:39]
  ds_read_b64 v[112:113], v5 offset:24896
  ds_read_b64 v[114:115], v5 offset:24904
  ds_read_b64 v[116:117], v5 offset:24832
  v_mfma_f32_16x16x32_bf16 v[40:43], v[56:59], v[120:123], v[40:43]
  ds_read_b64 v[118:119], v5 offset:24840
  ds_write_addtid_b32 v32 offset:4096
  v_mfma_f32_16x16x32_bf16 v[44:47], v[64:67], v[120:123], v[44:47]
  ds_write_addtid_b32 v33 offset:4352
  ds_write_addtid_b32 v34 offset:4608
  v_mfma_f32_16x16x32_bf16 v[36:39], v[52:55], v[124:127], v[36:39]
  ds_write_addtid_b32 v35 offset:4864
  v_mfma_f32_16x16x32_bf16 v[40:43], v[60:63], v[124:127], v[40:43]
  ds_read_b128 v[72:75], v6 offset:22848
  ds_read_b128 v[76:79], v6 offset:22784
  v_mfma_f32_16x16x32_bf16 v[44:47], v[68:71], v[124:127], v[44:47]
  v_mfma_f32_16x16x32_bf16 v[40:43], v[48:51], v[128:131], v[40:43]
  ds_write_addtid_b32 v36 offset:5120
  ds_write_addtid_b32 v37 offset:5376
  v_mfma_f32_16x16x32_bf16 v[44:47], v[56:59], v[128:131], v[44:47]
  ds_write_addtid_b32 v38 offset:5632
  v_mfma_f32_16x16x32_bf16 v[40:43], v[52:55], v[132:135], v[40:43]
  ds_write_addtid_b32 v39 offset:5888
  ds_read_b128 v[64:67], v6 offset:22336
  v_mfma_f32_16x16x32_bf16 v[44:47], v[60:63], v[132:135], v[44:47]
  ds_read_b128 v[68:71], v6 offset:22272
  s_waitcnt lgkmcnt(15)
  v_mfma_f32_16x16x32_bf16 v[44:47], v[48:51], v[136:139], v[44:47]
  v_mfma_f32_16x16x32_bf16 v[44:47], v[52:55], v[140:143], v[44:47]
  ds_write_addtid_b32 v40 offset:6144
  ds_write_addtid_b32 v41 offset:6400
  ds_write_addtid_b32 v42 offset:6656
  ds_write_addtid_b32 v43 offset:6912
  s_add_u32 s83, s83, 4
  s_add_u32 s85, s85, 4
  s_lshl_b32 s27, s34, 12
  s_add_u32 s27, s27, 18874368
  s_mov_b32 s34, s35
  s_mov_b32 s35, s76
  s_mov_b64 s[88:89], -1
  s_add_u32 s84, s84, 1
  ds_write_addtid_b32 v44 offset:7168
  ds_write_addtid_b32 v45 offset:7424
  ds_write_addtid_b32 v46 offset:7680
  ds_write_addtid_b32 v47 offset:7936
  s_mov_b64 exec, 1
  ds_add_u32 v2, v3 offset:0
  s_mov_b64 exec, -1
  ds_read_b128 v[56:59], v6 offset:21824
  ds_read_b128 v[60:63], v6 offset:21760
  ds_read_b128 v[48:51], v6 offset:21312
  ds_read_b128 v[52:55], v6 offset:21248
  v_add_u32 v5, 21248, v5
  v_add_u32 v6, 21248, v6
  s_cmp_lt_u32 s84, s77
  s_cbranch_scc1 cv_34
cs_39:
  ds_read_b32 v4, v2 offset:0
  s_waitcnt lgkmcnt(0)
  v_readfirstlane_b32 s26, v4
  s_cmp_lt_u32 s26, s83
  s_cbranch_scc1 cs_39
  ds_read_b128 v[144:147], v9 offset:0
  ds_read_b128 v[148:151], v9 offset:8192
  ds_read_b128 v[152:155], v9 offset:16384
  ds_read_b128 v[156:159], v9 offset:24576
  ds_read_b128 v[160:163], v9 offset:1024
  ds_read_b128 v[164:167], v9 offset:9216
  ds_read_b128 v[168:171], v9 offset:17408
  ds_read_b128 v[172:175], v9 offset:25600
  s_waitcnt lgkmcnt(6)
  v_add_f32 v144, v144, v148
  v_add_f32 v145, v145, v149
  v_add_f32 v146, v146, v150
  v_add_f32 v147, v147, v151
  s_waitcnt lgkmcnt(4)
  v_add_f32 v152, v152, v156
  v_add_f32 v153, v153, v157
  v_add_f32 v154, v154, v158
  v_add_f32 v155, v155, v159
  v_add_f32 v144, v144, v152
  v_add_f32 v145, v145, v153
  v_add_f32 v146, v146, v154
  v_add_f32 v147, v147, v155
  v_cvt_pk_bf16_f32 v176, v144, v145
  v_cvt_pk_bf16_f32 v177, v146, v147
  v_min_u32 v176, -2, v176
  v_min_u32 v177, -2, v177
  buffer_store_dwordx2 v[176:177], v11, s[12:15], s27 offen offset:0 sc1
  s_waitcnt lgkmcnt(2)
  v_add_f32 v160, v160, v164
  v_add_f32 v161, v161, v165
  v_add_f32 v162, v162, v166
  v_add_f32 v163, v163, v167
  s_waitcnt lgkmcnt(0)
  v_add_f32 v168, v168, v172
  v_add_f32 v169, v169, v173
  v_add_f32 v170, v170, v174
  v_add_f32 v171, v171, v175
  v_add_f32 v160, v160, v168
  v_add_f32 v161, v161, v169
  v_add_f32 v162, v162, v170
  v_add_f32 v163, v163, v171
  v_cvt_pk_bf16_f32 v178, v160, v161
  v_cvt_pk_bf16_f32 v179, v162, v163
  v_min_u32 v178, -2, v178
  v_min_u32 v179, -2, v179
  buffer_store_dwordx2 v[178:179], v11, s[12:15], s27 offen offset:512 sc1
  buffer_load_ushort v186, v10, s[72:75], 0 offen
  s_lshl_b32 s26, s21, 7
  v_lshlrev_b32 v4, 3, v1
  buffer_load_dwordx2 v[184:185], v4, s[72:75], s26 offen
  v_lshlrev_b32 v7, 4, v15
  buffer_load_dwordx4 v[180:183], v7, s[12:15], s87 offen
  s_mov_b64 exec, 1
  ds_add_u32 v2, v3 offset:8
  s_mov_b64 exec, -1
  s_waitcnt vmcnt(0)
  v_lshlrev_b32 v28, 16, v184
  v_and_b32 v29, 0xffff0000, v184
  v_lshlrev_b32 v30, 16, v185
  v_and_b32 v31, 0xffff0000, v185
  v_lshlrev_b32 v32, 16, v186
  v_fma_f32 v48, -v180, v28, v28
  v_fma_f32 v49, -v181, v28, v28
  v_fma_f32 v50, -v182, v28, v28
  v_fma_f32 v51, -v183, v28, v28
  v_fma_f32 v52, -v180, v29, v29
  v_fma_f32 v53, -v181, v29, v29
  v_fma_f32 v54, -v182, v29, v29
  v_fma_f32 v55, -v183, v29, v29
  v_fma_f32 v56, -v180, v30, v30
  v_fma_f32 v57, -v181, v30, v30
  v_fma_f32 v58, -v182, v30, v30
  v_fma_f32 v59, -v183, v30, v30
  v_fma_f32 v60, -v180, v31, v31
  v_fma_f32 v61, -v181, v31, v31
  v_fma_f32 v62, -v182, v31, v31
  v_fma_f32 v63, -v183, v31, v31
  v_fma_f32 v64, -v180, v32, v32
  v_fma_f32 v65, -v181, v32, v32
  v_fma_f32 v66, -v182, v32, v32
  v_fma_f32 v67, -v183, v32, v32
  s_add_u32 s78, s86, 4096
  s_add_u32 s79, s86, 8192
  s_add_u32 s80, s86, 12288
cw_40:
  s_sleep 1
  ds_read_b32 v4, v2 offset:8
  s_waitcnt lgkmcnt(0)
  v_readfirstlane_b32 s26, v4
  s_cmp_lt_u32 s26, 8
  s_cbranch_scc1 cw_40
  s_mov_b32 s28, 0x100000
pl_41:
  buffer_load_dwordx2 v[16:17], v12, s[12:15], s86 offen sc1
  buffer_load_dwordx2 v[18:19], v12, s[12:15], s78 offen sc1
  buffer_load_dwordx2 v[20:21], v12, s[12:15], s79 offen sc1
  buffer_load_dwordx2 v[22:23], v12, s[12:15], s80 offen sc1
  buffer_load_dwordx2 v[24:25], v13, s[12:15], s86 offen sc1
  s_sub_u32 s28, s28, 1
  s_cmp_eq_u32 s28, 0
  s_waitcnt vmcnt(0)
  s_cbranch_scc1 pd_42
  v_max3_u32 v4, v16, v17, v18
  v_max3_u32 v1, v19, v20, v21
  v_max3_u32 v4, v4, v22, v23
  v_max3_u32 v1, v1, v24, v25
  v_max_u32 v4, v4, v1
  v_cmp_eq_u32 vcc, -1, v4
  s_cbranch_vccz pd_42
  s_sleep 4
  s_branch pl_41
pd_42:
  v_lshlrev_b32 v98, 16, v16
  v_and_b32 v99, 0xffff0000, v16
  v_lshlrev_b32 v100, 16, v17
  v_and_b32 v101, 0xffff0000, v17
  v_fmac_f32 v48, v180, v98
  v_fmac_f32 v49, v181, v99
  v_fmac_f32 v50, v182, v100
  v_fmac_f32 v51, v183, v101
  ds_write_b128 v14, v[48:51] offset:0
  v_lshlrev_b32 v98, 16, v18
  v_and_b32 v99, 0xffff0000, v18
  v_lshlrev_b32 v100, 16, v19
  v_and_b32 v101, 0xffff0000, v19
  v_fmac_f32 v52, v180, v98
  v_fmac_f32 v53, v181, v99
  v_fmac_f32 v54, v182, v100
  v_fmac_f32 v55, v183, v101
  ds_write_b128 v14, v[52:55] offset:1024
  v_lshlrev_b32 v98, 16, v20
  v_and_b32 v99, 0xffff0000, v20
  v_lshlrev_b32 v100, 16, v21
  v_and_b32 v101, 0xffff0000, v21
  v_fmac_f32 v56, v180, v98
  v_fmac_f32 v57, v181, v99
  v_fmac_f32 v58, v182, v100
  v_fmac_f32 v59, v183, v101
  ds_write_b128 v14, v[56:59] offset:2048
  v_lshlrev_b32 v98, 16, v22
  v_and_b32 v99, 0xffff0000, v22
  v_lshlrev_b32 v100, 16, v23
  v_and_b32 v101, 0xffff0000, v23
  v_fmac_f32 v60, v180, v98
  v_fmac_f32 v61, v181, v99
  v_fmac_f32 v62, v182, v100
  v_fmac_f32 v63, v183, v101
  ds_write_b128 v14, v[60:63] offset:3072
  v_lshlrev_b32 v98, 16, v24
  v_and_b32 v99, 0xffff0000, v24
  v_lshlrev_b32 v100, 16, v25
  v_and_b32 v101, 0xffff0000, v25
  v_fmac_f32 v64, v180, v98
  v_fmac_f32 v65, v181, v99
  v_fmac_f32 v66, v182, v100
  v_fmac_f32 v67, v183, v101
  ds_write_b128 v14, v[64:67] offset:4096
  s_waitcnt lgkmcnt(0)
  s_barrier
  s_endpgm
end_26:
  s_endpgm
code_end:
.section .rodata,"a"
.p2align 6
.amdhsa_kernel k1_kernel
  .amdhsa_next_free_vgpr 256
  .amdhsa_next_free_sgpr 102
  .amdhsa_accum_offset 256
  .amdhsa_group_segment_fixed_size 0
  .amdhsa_kernarg_size 144
  .amdhsa_user_sgpr_count 2
  .amdhsa_user_sgpr_kernarg_segment_ptr 1
  .amdhsa_system_sgpr_workgroup_id_x 1
.end_amdhsa_kernel
.p2align 6
.amdhsa_kernel k2_kernel
  .amdhsa_next_free_vgpr 256
  .amdhsa_next_free_sgpr 102
  .amdhsa_accum_offset 256
  .amdhsa_group_segment_fixed_size 0
  .amdhsa_kernarg_size 144
  .amdhsa_user_sgpr_count 2
  .amdhsa_user_sgpr_kernarg_segment_ptr 1
  .amdhsa_system_sgpr_workgroup_id_x 1
.end_amdhsa_kernel
```
